```python
import torch

def _softmax(x, axis=-1):
    return torch.softmax(x, dim=axis)
def _gelu(x):
    return torch.nn.functional.gelu(x, approximate="tanh")
def _silu(x):
    return torch.nn.functional.silu(x)
def _sigmoid(x):
    return torch.sigmoid(x)
def _layernorm(x, axis=-1, eps=1e-5):
    m = x.mean(dim=axis, keepdim=True)
    v = x.var(dim=axis, keepdim=True, unbiased=False)
    return (x - m) / torch.sqrt(v + eps)
def _scatter_add(tgt, idx, src, axis=0):
    return tgt.clone().index_add_(axis, idx, src)
def _segment_sum(src, seg, n):
    out = torch.zeros((n,) + src.shape[1:], dtype=src.dtype)
    return out.index_add_(0, seg, src)
def _pad(x, pw):
    flat = tuple(v for pair in reversed(pw) for v in pair)
    return torch.nn.functional.pad(x, flat)

kernel_name = 'sequential_preLN__spectral_gfnet__dense_activation_silu__prompt'

def setup_inputs():

    _w = (lambda a: (lambda t: t.to(torch.bfloat16) if t.is_floating_point() else t)(torch.as_tensor(a)))
    def _A_setup():
        B, S, D = 1, 2048, 512
        Df = D // 2 + 1
        return {
            "x": _w((lambda *s: torch.randn(*s, dtype=torch.bfloat16) * 0.05)(B, S, D)),
            "w_r": _w((lambda *s: torch.randn(*s, dtype=torch.bfloat16) * 0.4)(S, Df) * 0.02),
            "w_i": _w((lambda *s: torch.randn(*s, dtype=torch.bfloat16) * 0.4)(S, Df) * 0.02),
        }
    _A_in = _A_setup()

    def _B_setup():
        B, S, D, F = 1, 2048, 512, 1376
        return {
            "x": _w((lambda *s: torch.randn(*s, dtype=torch.bfloat16) * 0.05)(B, S, D)),
            "w1": _w((lambda *s: torch.randn(*s, dtype=torch.bfloat16) * 0.8)(D, F) * (D ** -0.5)),
            "w2": _w((lambda *s: torch.randn(*s, dtype=torch.bfloat16) * 0.1)(F, D) * (F ** -0.5)),
        }
    _B_in = _B_setup()

    return {
        "A_x": _A_in["x"],
        "A_w_r": _A_in["w_r"],
        "A_w_i": _A_in["w_i"],
        "B_x": _B_in["x"],
        "B_w1": _B_in["w1"],
        "B_w2": _B_in["w2"],
    }

def reference(A_x, A_w_r, A_w_i, B_x, B_w1, B_w2):
    def _A_ref(x, w_r, w_i):
        B, S, D = x.shape
        X = (lambda x, axes=(-2,-1): torch.fft.rfft2(x.float(), dim=axes))(x, axes=(-2, -1))
        W = w_r + 1j * w_i
        X = X * W
        y = (lambda x, s, axes=(-2,-1): torch.fft.irfft2(x, s=s, dim=axes).to(torch.bfloat16))(X, (S, D), axes=(-2, -1))
        return y

    def _B_ref(x, w1, w2):
        h = torch.einsum("bsd,df->bsf", x, w1)
        h = _silu(h)
        out = torch.einsum("bsf,fd->bsd", h, w2)
        return out

    x = A_x
    h = x + _A_ref(_layernorm(x, axis=-1), A_w_r, A_w_i)
    h2 = h + _B_ref(_layernorm(h, axis=-1), B_w1, B_w2)
    return h2
```

```asm
; @launch grid=(256,1,1) block=(512,1,1) lds=163840
.amdgcn_target "amdgcn-amd-amdhsa--gfx950"
.text
.globl sequential_preLN__spectral_gfnet__dense_activation_silu__prompt_kernel
.p2align 8
.type sequential_preLN__spectral_gfnet__dense_activation_silu__prompt_kernel,@function
sequential_preLN__spectral_gfnet__dense_activation_silu__prompt_kernel:
    s_load_dwordx2 s[8:9], s[0:1], 0
    s_load_dwordx2 s[32:33], s[0:1], 64
    s_load_dwordx4 s[60:63], s[0:1], 8
    s_load_dwordx4 s[64:67], s[0:1], 32
    s_load_dwordx2 s[28:29], s[0:1], 48
    s_cmp_ge_u32 s2, 256
    s_cbranch_scc1 L_end
    s_getpc_b64 s[4:5]
    s_lshr_b32 s39, s2, 3
    s_and_b32 s42, s39, 3
    s_lshl_b32 s42, s42, 13
    v_lshrrev_b32 v1, 3, v0
    v_lshl_add_u32 v1, v1, 7, s42
    global_load_dword v7, v1, s[4:5]
    v_lshrrev_b32 v1, 6, v0
    v_and_b32 v5, 15, v0
    v_readfirstlane_b32 s3, v1
    v_bfe_u32 v6, v0, 4, 2
    s_and_b32 s38, s2, 7
    s_cmp_ge_u32 s3, 4
    s_cbranch_scc1 L_roleB
    s_lshl_b32 s37, s38, 4
    s_and_b32 s42, s39, 15
    s_or_b32 s37, s37, s42
    s_and_b32 s42, s2, 0x80
    s_or_b32 s37, s37, s42
    v_lshlrev_b32 v17, 2, v5
    v_lshl_add_u32 v17, v6, 8, v17
    s_lshl_b32 s42, s3, 19
    s_lshl_b32 s43, s37, 10
    s_add_u32 s56, s42, s43
    s_add_u32 s57, s56, 0x40000
    s_mov_b32 s10, 0x200000
    s_mov_b32 s11, 0x20000
    s_mov_b32 s34, 20971520
    s_mov_b32 s35, 0x20000
    s_mov_b32 s44, 14680064
    s_setprio 1
    s_waitcnt lgkmcnt(0)
    buffer_load_dword v18, v17, s[8:11], s56 offen offset:0
    buffer_load_dword v19, v17, s[8:11], s56 offen offset:64
    buffer_load_dword v20, v17, s[8:11], s56 offen offset:128
    buffer_load_dword v21, v17, s[8:11], s56 offen offset:192
    buffer_load_dword v22, v17, s[8:11], s57 offen offset:0
    buffer_load_dword v23, v17, s[8:11], s57 offen offset:64
    buffer_load_dword v24, v17, s[8:11], s57 offen offset:128
    buffer_load_dword v25, v17, s[8:11], s57 offen offset:192
    buffer_load_dword v26, off, s[32:35], s44 sc1
    s_branch L_contA
L_roleB:
    s_setprio 2
    v_and_b32 v4, 63, v0
    s_and_b32 s36, s3, 3
    s_cmp_eq_u32 s3, 7
    s_cbranch_scc1 L_w3_20
    s_xor_b32 s42, s2, 255
    s_mul_i32 s42, s42, 3
    s_add_u32 s76, s42, s36
    s_and_b32 s42, s76, 15
    s_mul_i32 s42, s42, 22016
    s_lshr_b32 s43, s76, 4
    s_lshl_b32 s43, s43, 7
    s_add_u32 s42, s42, s43
    s_sub_u32 s43, s76, 352
    s_and_b32 s44, s43, 7
    s_lshl_b32 s44, s44, 7
    s_lshr_b32 s43, s43, 3
    s_lshl_b32 s43, s43, 15
    s_add_u32 s43, s43, s44
    s_lshl_b32 s49, s36, 13
    s_add_u32 s49, s49, 66560
    s_mov_b32 m0, s49
    s_movk_i32 s48, 1024
    s_movk_i32 s53, 7168
    v_lshrrev_b32 v1, 3, v4
    v_and_b32 v12, 7, v0
    v_lshlrev_b32 v12, 4, v12
    s_mov_b32 s22, 1409024
    s_mov_b32 s23, 0x20000
    s_cmp_lt_u32 s76, 352
    s_cselect_b32 s51, s42, s43
    s_cselect_b32 s48, 2752, s48
    s_cselect_b32 s53, 351232, s53
    v_mad_u32_u24 v12, v1, s48, v12
    s_waitcnt lgkmcnt(0)
    s_cselect_b64 s[20:21], s[64:65], s[66:67]
    s_sleep 8
    buffer_load_dwordx4 v12, s[20:23], s51 offen offset:0 lds
    s_add_u32 s51, s51, s53
    buffer_load_dwordx4 v12, s[20:23], s51 offen offset:1024 lds
    s_add_u32 s51, s51, s53
    buffer_load_dwordx4 v12, s[20:23], s51 offen offset:2048 lds
    s_add_u32 s51, s51, s53
    buffer_load_dwordx4 v12, s[20:23], s51 offen offset:3072 lds
    s_mov_b64 s[12:13], s[60:61]
    s_mov_b32 s14, 1052672
    s_mov_b32 s15, 0x20000
    s_mov_b64 s[16:17], s[62:63]
    s_mov_b32 s18, 1052672
    s_mov_b32 s19, 0x20000
    s_branch L_join_21
L_w3_20:
    s_lshl_b32 s42, s39, 6
    s_add_u32 s42, s42, s38
    s_movk_i32 s76, 1023
    s_mov_b32 s49, 91136
    v_and_b32 v12, 28, v0
    v_lshl_add_u32 v12, v12, 1, s42
    v_cmp_gt_u32 vcc, 32, v4
    v_sub_u32 v14, 0, v12
    v_and_b32 v14, 2047, v14
    v_cndmask_b32 v12, v14, v12, vcc
    v_mul_u32_u24 v12, 514, v12
    v_and_b32 v14, 3, v0
    v_mul_u32_u24 v14, 84, v14
    v_and_b32 v1, 32, v0
    v_lshl_add_u32 v14, v1, 3, v14
    v_add_u32 v12, v12, v14
    s_waitcnt lgkmcnt(0)
    s_mov_b64 s[12:13], s[60:61]
    s_mov_b32 s14, 1052672
    s_mov_b32 s15, 0x20000
    s_mov_b64 s[16:17], s[62:63]
    s_mov_b32 s18, 1052672
    s_mov_b32 s19, 0x20000
    s_sleep 8
    buffer_load_dword v14, v12, s[12:15], 0 offen offset:2
    buffer_load_dword v15, v12, s[16:19], 0 offen offset:2
L_join_21:
    s_setprio 0
    s_branch L_contB
L_contA:
    v_and_b32 v4, 63, v0
    s_and_b32 s36, s3, 3
    s_lshl_b32 s50, s38, 5
    s_or_b32 s50, s50, s39
    s_and_b32 s40, s39, 7
    s_lshr_b32 s41, s39, 3
    s_mul_i32 s41, s41, 0
    s_mul_i32 s42, s38, 4
    s_xor_b32 s41, s41, s42
    s_and_b32 s41, s41, 12
    v_mov_b32 v3, 0
    v_lshlrev_b32 v2, 4, v4
    s_lshl_b32 s42, s50, 13
    s_lshl_b32 s43, s36, 11
    s_add_u32 s55, s42, s43
    s_mul_i32 s49, s36, 16128
    s_add_u32 s49, s49, 99328
    s_mov_b32 s45, 0x3f803f80
    s_mov_b32 s46, 0x00030003
    v_add_u32 v12, s49, v2
    v_mov_b32 v1, s49
    ds_write_b32 v1, v3 offset:15360
    v_mul_u32_u24 v17, v5, v6
    v_cvt_f32_u32 v62, v5
    v_cvt_f32_u32 v17, v17
    v_mul_f32 v17, 0x3c800000, v17
    v_mul_f32 v1, 0x41800000, v17
    v_fract_f32 v1, v1
    v_cos_f32 v27, v1
    v_sin_f32 v60, v1
    v_cos_f32 v44, v17
    v_sin_f32 v48, v17
    v_cvt_pk_bf16_f32 v28, v27, v60
    v_cvt_pk_bf16_f32 v32, -v60, v27
    v_cvt_pk_f16_f32 v36, v27, v60
    v_cvt_pk_f16_f32 v40, -v60, v27
    v_fmamk_f32 v17, v62, 0x3b800000, v17
    v_mul_f32 v1, 0x41800000, v17
    v_fract_f32 v1, v1
    v_cos_f32 v27, v1
    v_sin_f32 v60, v1
    v_cos_f32 v45, v17
    v_sin_f32 v49, v17
    v_cvt_pk_bf16_f32 v29, v27, v60
    v_cvt_pk_bf16_f32 v33, -v60, v27
    v_cvt_pk_f16_f32 v37, v27, v60
    v_cvt_pk_f16_f32 v41, -v60, v27
    v_fmamk_f32 v17, v62, 0x3b800000, v17
    v_mul_f32 v1, 0x41800000, v17
    v_fract_f32 v1, v1
    v_cos_f32 v27, v1
    v_sin_f32 v60, v1
    v_cos_f32 v46, v17
    v_sin_f32 v50, v17
    v_cvt_pk_bf16_f32 v30, v27, v60
    v_cvt_pk_bf16_f32 v34, -v60, v27
    v_cvt_pk_f16_f32 v38, v27, v60
    v_cvt_pk_f16_f32 v42, -v60, v27
    v_fmamk_f32 v17, v62, 0x3b800000, v17
    v_mul_f32 v1, 0x41800000, v17
    v_fract_f32 v1, v1
    v_cos_f32 v27, v1
    v_sin_f32 v60, v1
    v_cos_f32 v47, v17
    v_sin_f32 v51, v17
    v_cvt_pk_bf16_f32 v31, v27, v60
    v_cvt_pk_bf16_f32 v35, -v60, v27
    v_cvt_pk_f16_f32 v39, v27, v60
    v_cvt_pk_f16_f32 v43, -v60, v27
    v_lshrrev_b32 v61, 1, v5
    v_and_b32 v17, 1, v6
    v_lshl_add_u32 v17, v17, 10, s37
    v_mul_u32_u24 v17, v17, v61
    v_cvt_f32_u32 v62, v61
    v_cvt_f32_u32 v17, v17
    v_lshrrev_b32 v63, 1, v6
    v_mul_f32 v17, 0x3a000000, v17
    v_xor_b32 v63, v63, v5
    v_and_b32 v63, 1, v63
    v_add_u32 v63, -1, v63
    v_lshlrev_b32 v64, 31, v5
    v_cos_f32 v27, v17
    v_sin_f32 v60, v17
    s_nop 0
    v_cvt_pk_f16_f32 v52, v27, v60
    v_cvt_pk_f16_f32 v56, -v60, v27
    v_bitop3_b32 v52, v52, v64, v63 bitop3:0x28
    v_bitop3_b32 v56, v56, v64, v63 bitop3:0x28
    v_fmamk_f32 v17, v62, 0x3e000000, v17
    v_cos_f32 v27, v17
    v_sin_f32 v60, v17
    s_nop 0
    v_cvt_pk_f16_f32 v53, v27, v60
    v_cvt_pk_f16_f32 v57, -v60, v27
    v_bitop3_b32 v53, v53, v64, v63 bitop3:0x28
    v_bitop3_b32 v57, v57, v64, v63 bitop3:0x28
    v_fmamk_f32 v17, v62, 0x3e000000, v17
    v_cos_f32 v27, v17
    v_sin_f32 v60, v17
    s_nop 0
    v_cvt_pk_f16_f32 v54, v27, v60
    v_cvt_pk_f16_f32 v58, -v60, v27
    v_bitop3_b32 v54, v54, v64, v63 bitop3:0x28
    v_bitop3_b32 v58, v58, v64, v63 bitop3:0x28
    v_fmamk_f32 v17, v62, 0x3e000000, v17
    v_cos_f32 v27, v17
    v_sin_f32 v60, v17
    s_nop 0
    v_cvt_pk_f16_f32 v55, v27, v60
    v_cvt_pk_f16_f32 v59, -v60, v27
    v_bitop3_b32 v55, v55, v64, v63 bitop3:0x28
    v_bitop3_b32 v59, v59, v64, v63 bitop3:0x28
    s_lshr_b32 s42, s36, 1
    s_lshl_b32 s42, s42, 12
    s_and_b32 s43, s36, 1
    s_lshl_b32 s43, s43, 3
    s_add_u32 s42, s42, s43
    s_add_u32 s42, s42, 0
    v_lshl_add_u32 v17, v5, 4, s42
    v_lshl_add_u32 v17, v6, 10, v17
    v_and_b32 v66, 1, v6
    v_lshlrev_b32 v61, 18, v61
    v_lshl_add_u32 v61, v66, 4, v61
    v_and_b32 v1, 2, v6
    v_and_or_b32 v1, v5, 1, v1
    v_lshl_add_u32 v60, v1, 5, v61
    s_movk_i32 s43, 0
    v_lshl_add_u32 v66, v66, 8, s43
    s_lshl_b32 s42, s36, 5
    v_add_u32 v64, s42, v5
    v_cmp_eq_u32 vcc, 0, v64
    v_cmp_lt_u32 s[4:5], 1, v6
    v_sub_u32 v27, 256, v64
    v_add_u32 v65, 16, v64
    v_add_u32 v61, -16, v27
    v_mov_b32 v1, 128
    v_cndmask_b32 v27, v27, v1, vcc
    v_cndmask_b32 v64, v64, v27, s[4:5]
    v_cndmask_b32 v65, v65, v61, s[4:5]
    v_cmp_eq_u32 vcc, 0, v5
    v_add_lshl_u32 v64, v64, v66, 4
    v_add_lshl_u32 v65, v65, v66, 4
    v_mov_b32 v1, 0x41800000
    v_cndmask_b32 v62, 0, v1, vcc
    v_mov_b32 v66, 0
    v_mov_b32 v67, 0
    v_mov_b32 v68, 0
    v_mov_b32 v69, 0
    s_lshl_b32 s42, s36, 16
    s_lshl_b32 s43, s2, 7
    s_add_u32 s58, s42, s43
    s_add_u32 s59, s58, 32768
    s_mov_b64 s[12:13], s[60:61]
    s_mov_b32 s14, 1052672
    s_mov_b32 s15, 0x20000
    s_mov_b64 s[16:17], s[62:63]
    s_mov_b32 s18, 1052672
    s_mov_b32 s19, 0x20000
    s_lshl_b32 s42, s36, 5
    s_and_b32 s43, s2, 15
    s_add_u32 s42, s42, s43
    v_and_b32 v61, 0x19, v4
    v_lshl_add_u32 v61, v61, 4, s42
    v_and_b32 v1, 6, v4
    v_lshl_add_u32 v61, v1, 8, v61
    v_cmp_gt_u32 vcc, 32, v4
    s_lshr_b32 s42, s39, 1
    s_lshl_b32 s42, s42, 4
    s_sub_u32 s43, 498, s42
    v_sub_u32 v74, 0, v61
    v_and_b32 v74, 2047, v74
    v_mul_u32_u24 v61, 514, v61
    v_mul_u32_u24 v74, 514, v74
    v_add_u32 v1, s42, v61
    v_add_u32 v74, s43, v74
    v_cndmask_b32 v75, v74, v1, vcc
    v_cndmask_b32 v76, 2.0, v61, vcc
    s_cmp_ge_u32 s39, 2
    s_cselect_b32 s65, 2.0, 0
    s_waitcnt vmcnt(5)
    v_mfma_f32_16x16x32_bf16 v[88:91], v[18:21], v[28:31], 0
    v_mfma_f32_16x16x32_bf16 v[92:95], v[18:21], v[32:35], 0
    s_waitcnt vmcnt(1)
    v_mfma_f32_16x16x32_bf16 v[96:99], v[22:25], v[28:31], 0
    v_mfma_f32_16x16x32_bf16 v[100:103], v[22:25], v[32:35], 0
    v_dot2c_f32_bf16 v66, s45, v18
    v_dot2c_f32_bf16 v68, v18, v18
    v_dot2c_f32_bf16 v66, s45, v19
    v_dot2c_f32_bf16 v68, v19, v19
    v_dot2c_f32_bf16 v66, s45, v20
    v_dot2c_f32_bf16 v68, v20, v20
    v_dot2c_f32_bf16 v66, s45, v21
    v_dot2c_f32_bf16 v68, v21, v21
    v_dot2c_f32_bf16 v67, s45, v22
    v_dot2c_f32_bf16 v69, v22, v22
    v_dot2c_f32_bf16 v67, s45, v23
    v_dot2c_f32_bf16 v69, v23, v23
    v_dot2c_f32_bf16 v67, s45, v24
    v_dot2c_f32_bf16 v69, v24, v24
    v_dot2c_f32_bf16 v67, s45, v25
    v_dot2c_f32_bf16 v69, v25, v25
    s_waitcnt vmcnt(0)
    v_readfirstlane_b32 s47, v26
    v_and_b32 v26, 1, v6
    v_permlane32_swap_b32 v66, v67
    v_lshlrev_b32 v26, 4, v26
    v_permlane32_swap_b32 v68, v69
    s_add_u32 s44, s47, 1
    v_add_f32 v66, v66, v67
    s_and_b32 s44, s44, 15
    v_add_f32 v68, v68, v69
    s_and_b32 s47, s47, 0xfffffff0
    s_and_b32 s48, s47, 0xfefefef0
    v_permlane16_swap_b32 v66, v68
    s_or_b32 s48, s48, 0x10101010
    v_add_f32 v66, v66, v68
    s_or_b32 s47, s47, s44
    s_nop 0
    v_add_f32_dpp v66, v66, v66 row_ror:8 row_mask:0xf bank_mask:0xf
    s_mul_i32 s44, s44, 0x01010101
    s_nop 0
    v_add_f32_dpp v66, v66, v66 row_ror:4 row_mask:0xf bank_mask:0xf
    s_and_b32 s53, s48, 0x0f0f0f0f
    s_nop 0
    v_add_f32_dpp v66, v66, v66 row_ror:2 row_mask:0xf bank_mask:0xf
    s_add_u32 s53, s53, s44
    s_and_b32 s53, s53, 0x0f0f0f0f
    v_add_f32_dpp v66, v66, v66 row_ror:1 row_mask:0xf bank_mask:0xf
    s_lshr_b32 s48, s48, 4
    v_mul_f32 v68, 0x3b000000, v66
    s_and_b32 s48, s48, 0x0f0f0f0f
    v_mul_f32 v66, 0x3b000000, v66
    s_add_u32 s48, s48, s44
    s_nop 0
    v_permlane16_swap_b32 v66, v68
    s_and_b32 s48, s48, 0x0f0f0f0f
    v_fma_f32 v68, -v66, v66, v68
    s_lshl_b32 s48, s48, 4
    s_or_b32 s79, s48, s53
    v_max_f32 v68, 0, v68
    v_bfe_u32 v26, s79, v26, 16
    v_add_f32 v68, 0x3727c5ac, v68
    v_and_b32 v7, 7, v5
    v_rsq_f32 v68, v68
    v_lshlrev_b32 v7, 2, v7
    v_mov_b32 v27, v66
    v_lshl_or_b32 v128, v26, 14, v26
    v_mul_f32 v66, v62, v66
    v_bfe_u32 v7, s79, v7, 4
    v_lshrrev_b32 v129, 4, v128
    v_mul_f32 v70, v66, v68
    v_lshrrev_b32 v130, 8, v128
    v_mul_f32 v72, v66, v68
    v_lshrrev_b32 v131, 12, v128
    v_mov_b32 v66, v68
    v_lshl_or_b32 v7, v7, 14, v7
    v_permlane32_swap_b32 v70, v72
    v_and_b32 v61, s46, v7
    v_permlane32_swap_b32 v66, v68
    v_pk_mul_f32 v[120:121], v[44:45], v[66:67] op_sel_hi:[1,0]
    v_pk_mul_f32 v[122:123], v[46:47], v[66:67] op_sel_hi:[1,0]
    v_pk_mul_f32 v[124:125], v[48:49], v[66:67] op_sel_hi:[1,0]
    v_pk_mul_f32 v[126:127], v[50:51], v[66:67] op_sel_hi:[1,0]
    v_pk_fma_f32 v[104:105], v[88:89], v[120:121], v[70:71] op_sel_hi:[1,1,0] neg_lo:[0,0,1] neg_hi:[0,0,1]
    v_pk_fma_f32 v[108:109], v[92:93], v[120:121], v[70:71] op_sel_hi:[1,1,0] neg_lo:[0,0,1] neg_hi:[0,0,1]
    v_pk_fma_f32 v[106:107], v[90:91], v[122:123], v[70:71] op_sel_hi:[1,1,0] neg_lo:[0,0,1] neg_hi:[0,0,1]
    v_pk_fma_f32 v[110:111], v[94:95], v[122:123], v[70:71] op_sel_hi:[1,1,0] neg_lo:[0,0,1] neg_hi:[0,0,1]
    v_pk_fma_f32 v[104:105], v[92:93], v[124:125], v[104:105]
    v_pk_fma_f32 v[108:109], v[88:89], v[124:125], v[108:109] neg_lo:[0,1,0] neg_hi:[0,1,0]
    v_pk_fma_f32 v[106:107], v[94:95], v[126:127], v[106:107]
    v_pk_fma_f32 v[110:111], v[90:91], v[126:127], v[110:111] neg_lo:[0,1,0] neg_hi:[0,1,0]
    v_cvt_pk_f16_f32 v18, v104, v108
    v_cvt_pk_f16_f32 v19, v105, v109
    v_cvt_pk_f16_f32 v20, v106, v110
    v_cvt_pk_f16_f32 v21, v107, v111
    s_nop 1
    v_mfma_f32_16x16x32_f16 v[88:91], v[36:39], v[18:21], 0
    v_mfma_f32_16x16x32_f16 v[92:95], v[40:43], v[18:21], 0
    v_pk_mul_f32 v[120:121], v[44:45], v[68:69] op_sel_hi:[1,0]
    v_pk_mul_f32 v[122:123], v[46:47], v[68:69] op_sel_hi:[1,0]
    v_pk_mul_f32 v[124:125], v[48:49], v[68:69] op_sel_hi:[1,0]
    v_pk_mul_f32 v[126:127], v[50:51], v[68:69] op_sel_hi:[1,0]
    v_pk_fma_f32 v[112:113], v[96:97], v[120:121], v[72:73] op_sel_hi:[1,1,0] neg_lo:[0,0,1] neg_hi:[0,0,1]
    v_pk_fma_f32 v[116:117], v[100:101], v[120:121], v[72:73] op_sel_hi:[1,1,0] neg_lo:[0,0,1] neg_hi:[0,0,1]
    v_pk_fma_f32 v[114:115], v[98:99], v[122:123], v[72:73] op_sel_hi:[1,1,0] neg_lo:[0,0,1] neg_hi:[0,0,1]
    v_pk_fma_f32 v[118:119], v[102:103], v[122:123], v[72:73] op_sel_hi:[1,1,0] neg_lo:[0,0,1] neg_hi:[0,0,1]
    v_pk_fma_f32 v[112:113], v[100:101], v[124:125], v[112:113]
    v_pk_fma_f32 v[116:117], v[96:97], v[124:125], v[116:117] neg_lo:[0,1,0] neg_hi:[0,1,0]
    v_pk_fma_f32 v[114:115], v[102:103], v[126:127], v[114:115]
    v_pk_fma_f32 v[118:119], v[98:99], v[126:127], v[118:119] neg_lo:[0,1,0] neg_hi:[0,1,0]
    v_cvt_pk_f16_f32 v22, v112, v116
    v_cvt_pk_f16_f32 v23, v113, v117
    v_cvt_pk_f16_f32 v24, v114, v118
    v_cvt_pk_f16_f32 v25, v115, v119
    s_nop 1
    v_mfma_f32_16x16x32_f16 v[96:99], v[36:39], v[22:25], 0
    v_mfma_f32_16x16x32_f16 v[100:103], v[40:43], v[22:25], 0
    v_cvt_pk_f16_f32 v104, v88, v92
    v_cvt_pk_f16_f32 v106, v89, v93
    v_cvt_pk_f16_f32 v108, v90, v94
    v_cvt_pk_f16_f32 v110, v91, v95
    s_nop 3
    v_cvt_pk_f16_f32 v105, v96, v100
    ds_write_b64 v17, v[104:105] offset:0
    v_cvt_pk_f16_f32 v107, v97, v101
    ds_write_b64 v17, v[106:107] offset:256
    v_cvt_pk_f16_f32 v109, v98, v102
    ds_write_b64 v17, v[108:109] offset:512
    v_cvt_pk_f16_f32 v111, v99, v103
    ds_write_b64 v17, v[110:111] offset:768
    s_waitcnt lgkmcnt(0)
    s_barrier
    ds_read_b128 v[18:21], v64
    ds_read_b128 v[22:25], v65
    s_waitcnt lgkmcnt(1)
    v_mfma_f32_16x16x32_f16 v[88:91], v[18:21], v[52:55], 0
    v_mfma_f32_16x16x32_f16 v[92:95], v[18:21], v[56:59], 0
    s_waitcnt lgkmcnt(0)
    v_mfma_f32_16x16x32_f16 v[96:99], v[22:25], v[52:55], 0
    v_mfma_f32_16x16x32_f16 v[100:103], v[22:25], v[56:59], 0
    s_nop 4
    v_cvt_pk_f16_f32 v104, v88, v92
    v_cvt_pk_f16_f32 v105, v89, v93
    v_cvt_pk_f16_f32 v106, v90, v94
    v_cvt_pk_f16_f32 v107, v91, v95
    v_bfi_b32 v104, s46, v128, v104
    v_bfi_b32 v105, s46, v129, v105
    v_bfi_b32 v106, s46, v130, v106
    v_bfi_b32 v107, s46, v131, v107
    buffer_store_dwordx4 v[104:107], v60, s[32:35], s58 offen sc1
    v_cvt_pk_f16_f32 v108, v96, v100
    v_cvt_pk_f16_f32 v109, v97, v101
    v_cvt_pk_f16_f32 v110, v98, v102
    v_cvt_pk_f16_f32 v111, v99, v103
    v_bfi_b32 v108, s46, v128, v108
    v_bfi_b32 v109, s46, v129, v109
    v_bfi_b32 v110, s46, v130, v110
    v_bfi_b32 v111, s46, v131, v111
    buffer_store_dwordx4 v[108:111], v60, s[32:35], s59 offen sc1
    s_barrier
    buffer_load_dwordx4 v[78:81], v75, s[12:15], 0 offen
    buffer_load_dwordx4 v[82:85], v75, s[16:19], 0 offen
    buffer_load_ushort v86, v76, s[12:15], s65 offen offset:256
    buffer_load_ushort v87, v76, s[16:19], s65 offen offset:256
    v_lshlrev_b32 v1, 2, v5
    v_lshl_add_u32 v8, v6, 9, v1
    v_lshrrev_b32 v1, 1, v6
    v_mul_u32_u24 v1, 15360, v1
    v_add_u32 v7, v1, v8
    s_lshr_b32 s42, s50, 2
    s_lshl_b32 s42, s42, 15
    s_lshl_b32 s43, s36, 12
    s_add_u32 s42, s42, s43
    s_and_b32 s43, s39, 2
    s_lshl_b32 s43, s43, 5
    s_add_u32 s60, s42, s43
    s_and_b32 s42, s39, 1
    s_lshl_b32 s43, s36, 2
    v_and_or_b32 v9, v5, 14, s42
    v_lshl_add_u32 v10, v6, 6, s43
    v_and_b32 v1, 1, v5
    v_lshlrev_b32 v1, 6, v1
    v_mad_u32_u24 v10, v10, v9, v1
    v_and_b32 v10, 255, v10
    v_cvt_f32_u32 v9, v9
    v_cvt_f32_u32 v10, v10
    v_mul_f32 v10, 0x3b800000, v10
    v_cos_f32 v17, v10
    v_sin_f32 v19, v10
    v_fmamk_f32 v1, v9, 0x3d800000, v10
    v_cos_f32 v18, v1
    v_sin_f32 v20, v1
    v_cvt_pk_f16_f32 v88, v17, v19
    v_fmamk_f32 v1, v9, 0x3e000000, v10
    v_cos_f32 v17, v1
    v_sin_f32 v19, v1
    v_cvt_pk_f16_f32 v89, v18, v20
    v_fmamk_f32 v1, v9, 0x3e400000, v10
    v_cos_f32 v18, v1
    v_sin_f32 v20, v1
    v_cvt_pk_f16_f32 v90, v17, v19
    v_fmamk_f32 v1, v9, 0x3b800000, v10
    v_cos_f32 v17, v1
    v_sin_f32 v19, v1
    v_cvt_pk_f16_f32 v91, v18, v20
    v_fmamk_f32 v1, v9, 0x3d880000, v10
    v_cos_f32 v18, v1
    v_sin_f32 v20, v1
    v_cvt_pk_f16_f32 v92, v17, v19
    v_fmamk_f32 v1, v9, 0x3e040000, v10
    v_cos_f32 v17, v1
    v_sin_f32 v19, v1
    v_cvt_pk_f16_f32 v93, v18, v20
    v_fmamk_f32 v1, v9, 0x3e440000, v10
    v_cos_f32 v18, v1
    v_sin_f32 v20, v1
    v_cvt_pk_f16_f32 v94, v17, v19
    v_fmamk_f32 v1, v9, 0x3c000000, v10
    v_cos_f32 v17, v1
    v_sin_f32 v19, v1
    v_cvt_pk_f16_f32 v95, v18, v20
    v_fmamk_f32 v1, v9, 0x3d900000, v10
    v_cos_f32 v18, v1
    v_sin_f32 v20, v1
    v_cvt_pk_f16_f32 v96, v17, v19
    v_fmamk_f32 v1, v9, 0x3e080000, v10
    v_cos_f32 v17, v1
    v_sin_f32 v19, v1
    v_cvt_pk_f16_f32 v97, v18, v20
    v_fmamk_f32 v1, v9, 0x3e480000, v10
    v_cos_f32 v18, v1
    v_sin_f32 v20, v1
    v_cvt_pk_f16_f32 v98, v17, v19
    v_fmamk_f32 v1, v9, 0x3c400000, v10
    v_cos_f32 v17, v1
    v_sin_f32 v19, v1
    v_cvt_pk_f16_f32 v99, v18, v20
    v_fmamk_f32 v1, v9, 0x3d980000, v10
    v_cos_f32 v18, v1
    v_sin_f32 v20, v1
    v_cvt_pk_f16_f32 v100, v17, v19
    v_fmamk_f32 v1, v9, 0x3e0c0000, v10
    v_cos_f32 v17, v1
    v_sin_f32 v19, v1
    v_cvt_pk_f16_f32 v101, v18, v20
    v_fmamk_f32 v1, v9, 0x3e4c0000, v10
    v_cos_f32 v18, v1
    v_sin_f32 v20, v1
    v_cvt_pk_f16_f32 v102, v17, v19
    v_cvt_pk_f16_f32 v103, v18, v20
    s_and_b32 s42, s39, 1
    s_lshl_b32 s43, s36, 2
    v_and_or_b32 v9, v5, 1, s43
    v_and_b32 v19, 1, v6
    v_lshlrev_b32 v19, 2, v19
    v_and_b32 v10, 14, v5
    v_lshl_add_u32 v10, v10, 3, v9
    v_lshlrev_b32 v10, 1, v10
    v_mul_u32_u24 v11, s42, v9
    v_mad_u32_u24 v11, v19, v10, v11
    v_cvt_f32_u32 v10, v10
    v_cvt_f32_u32 v11, v11
    v_mul_f32 v11, 0x3b800000, v11
    v_cos_f32 v17, v11
    v_sin_f32 v18, v11
    v_and_b32 v17, v63, v17
    v_and_b32 v18, v63, v18
    v_cvt_pk_bf16_f32 v104, v17, -v18
    v_cvt_pk_bf16_f32 v108, v18, v17
    v_fmamk_f32 v11, v10, 0x3b800000, v11
    v_cos_f32 v17, v11
    v_sin_f32 v18, v11
    v_and_b32 v17, v63, v17
    v_and_b32 v18, v63, v18
    v_cvt_pk_bf16_f32 v105, v17, -v18
    v_cvt_pk_bf16_f32 v109, v18, v17
    v_fmamk_f32 v11, v10, 0x3b800000, v11
    v_cos_f32 v17, v11
    v_sin_f32 v18, v11
    v_and_b32 v17, v63, v17
    v_and_b32 v18, v63, v18
    v_cvt_pk_bf16_f32 v106, v17, -v18
    v_cvt_pk_bf16_f32 v110, v18, v17
    v_fmamk_f32 v11, v10, 0x3b800000, v11
    v_cos_f32 v17, v11
    v_sin_f32 v18, v11
    v_and_b32 v17, v63, v17
    v_and_b32 v18, v63, v18
    v_cvt_pk_bf16_f32 v107, v17, -v18
    v_cvt_pk_bf16_f32 v111, v18, v17
    v_add_u32 v9, 2, v9
    v_and_b32 v10, 14, v5
    v_lshl_add_u32 v10, v10, 3, v9
    v_lshlrev_b32 v10, 1, v10
    v_mul_u32_u24 v11, s42, v9
    v_mad_u32_u24 v11, v19, v10, v11
    v_cvt_f32_u32 v10, v10
    v_cvt_f32_u32 v11, v11
    v_mul_f32 v11, 0x3b800000, v11
    v_cos_f32 v17, v11
    v_sin_f32 v18, v11
    v_and_b32 v17, v63, v17
    v_and_b32 v18, v63, v18
    v_cvt_pk_bf16_f32 v112, v17, -v18
    v_cvt_pk_bf16_f32 v116, v18, v17
    v_fmamk_f32 v11, v10, 0x3b800000, v11
    v_cos_f32 v17, v11
    v_sin_f32 v18, v11
    v_and_b32 v17, v63, v17
    v_and_b32 v18, v63, v18
    v_cvt_pk_bf16_f32 v113, v17, -v18
    v_cvt_pk_bf16_f32 v117, v18, v17
    v_fmamk_f32 v11, v10, 0x3b800000, v11
    v_cos_f32 v17, v11
    v_sin_f32 v18, v11
    v_and_b32 v17, v63, v17
    v_and_b32 v18, v63, v18
    v_cvt_pk_bf16_f32 v114, v17, -v18
    v_cvt_pk_bf16_f32 v118, v18, v17
    v_fmamk_f32 v11, v10, 0x3b800000, v11
    v_cos_f32 v17, v11
    v_sin_f32 v18, v11
    v_and_b32 v17, v63, v17
    v_and_b32 v18, v63, v18
    v_cvt_pk_bf16_f32 v115, v17, -v18
    v_cvt_pk_bf16_f32 v119, v18, v17
    v_lshrrev_b32 v20, 1, v5
    v_and_b32 v21, 1, v5
    s_lshl_b32 s42, s36, 11
    s_add_u32 s42, s42, 8448
    v_and_b32 v1, 8, v5
    v_add_lshl_u32 v19, v1, v5, 4
    v_lshl_add_u32 v19, v6, 9, v19
    v_add_u32 v9, s42, v19
    s_lshl_b32 s42, s36, 9
    s_add_u32 s42, s42, 8448
    v_lshl_add_u32 v19, v6, 11, s42
    v_lshl_add_u32 v19, v21, 7, v19
    v_lshl_add_u32 v10, v20, 4, v19
    s_lshr_b32 s42, s36, 1
    s_lshl_b32 s42, s42, 8
    s_and_b32 s43, s36, 1
    s_lshl_b32 s43, s43, 3
    s_add_u32 s42, s42, s43
    s_add_u32 s42, s42, 0
    v_mul_u32_u24 v19, 528, v5
    v_lshl_add_u32 v19, v6, 5, v19
    v_add_u32 v11, s42, v19
    s_mul_i32 s42, s36, 2112
    s_add_u32 s42, s42, 0
    v_lshrrev_b32 v1, 1, v6
    v_lshl_add_u32 v19, v1, 4, s42
    v_add_u32 v17, v2, v19
    v_lshlrev_b32 v19, 18, v20
    v_lshl_add_u32 v19, v21, 6, v19
    v_lshl_add_u32 v18, v6, 4, v19
    v_lshlrev_b32 v19, 3, v6
    v_bfe_u32 v19, s79, v19, 8
    v_lshl_or_b32 v22, v19, 15, v19
    v_lshrrev_b32 v23, 2, v22
    v_lshrrev_b32 v24, 4, v22
    v_lshrrev_b32 v25, 6, v22
    v_lshlrev_b32 v19, 1, v5
    v_bfe_u32 v19, s79, v19, 2
    v_lshl_or_b32 v19, v19, 15, v19
    v_and_b32 v26, 0x10001, v19
    s_lshl_b32 s42, s36, 16
    s_lshl_b32 s43, s2, 7
    s_add_u32 s42, s42, s43
    s_add_u32 s62, s42, 2097152
    s_add_u32 s63, s42, 2129920
    s_or_b32 s42, s2, s36
    s_cmp_lg_u32 s42, 0
    s_cselect_b32 s64, 2.0, 14680064
    buffer_load_dword v120, v7, s[32:35], s60 offen offset:0 sc1
    buffer_load_dword v121, v7, s[32:35], s60 offen offset:128 sc1
    buffer_load_dword v122, v7, s[32:35], s60 offen offset:256 sc1
    buffer_load_dword v123, v7, s[32:35], s60 offen offset:384 sc1
    buffer_load_dword v124, v7, s[32:35], s60 offen offset:1024 sc1
    buffer_load_dword v125, v7, s[32:35], s60 offen offset:1152 sc1
    buffer_load_dword v126, v7, s[32:35], s60 offen offset:1280 sc1
    buffer_load_dword v127, v7, s[32:35], s60 offen offset:1408 sc1
    buffer_load_dword v128, v7, s[32:35], s60 offen offset:2048 sc1
    buffer_load_dword v129, v7, s[32:35], s60 offen offset:2176 sc1
    buffer_load_dword v130, v7, s[32:35], s60 offen offset:2304 sc1
    buffer_load_dword v131, v7, s[32:35], s60 offen offset:2432 sc1
    buffer_load_dword v132, v7, s[32:35], s60 offen offset:3072 sc1
    buffer_load_dword v133, v7, s[32:35], s60 offen offset:3200 sc1
    buffer_load_dword v134, v7, s[32:35], s60 offen offset:3328 sc1
    buffer_load_dword v135, v7, s[32:35], s60 offen offset:3456 sc1
    s_add_u32 s42, s49, 4096
    v_add_u32 v19, s42, v2
    v_and_b32 v1, 1, v5
    v_lshl_add_u32 v1, v6, 1, v1
    v_lshl_add_u32 v1, v1, 4, s42
    v_and_or_b32 v20, v5, 14, v1
    v_xor_b32 v21, 14, v20
    v_mov_b32 v136, 0
    v_mov_b32 v137, 0
    v_mov_b32 v138, 0
    v_mov_b32 v139, 0
    v_mov_b32 v140, 0
    v_mov_b32 v141, 0
    v_mov_b32 v142, 0
    v_mov_b32 v143, 0
    v_mov_b32 v144, 0
    v_mov_b32 v145, 0
    v_mov_b32 v146, 0
    v_mov_b32 v147, 0
    v_mov_b32 v148, 0
    v_mov_b32 v149, 0
    v_mov_b32 v150, 0
    v_mov_b32 v151, 0
    s_waitcnt vmcnt(19)
    ds_write_b128 v19, v[78:81] offset:0
    s_waitcnt vmcnt(18)
    ds_write_b128 v19, v[82:85] offset:1024
    s_waitcnt vmcnt(16)
    v_mov_b32 v87, v87
    s_cmp_ge_u32 s39, 2
    s_cbranch_scc1 L_nor_1
    s_mov_b32 exec_hi, 0
    ds_write_b16 v19, v86 offset:0
    ds_write_b16 v19, v87 offset:1024
    s_mov_b32 exec_hi, -1
L_nor_1:
    ds_read_u16_d16_hi v136, v20 offset:0
    ds_read_u16_d16_hi v144, v21 offset:512
    ds_read_u16_d16_hi v140, v20 offset:1024
    ds_read_u16_d16_hi v148, v21 offset:1536
    ds_read_u16_d16_hi v137, v20 offset:128
    ds_read_u16_d16_hi v145, v21 offset:640
    ds_read_u16_d16_hi v141, v20 offset:1152
    ds_read_u16_d16_hi v149, v21 offset:1664
    ds_read_u16_d16_hi v138, v20 offset:256
    ds_read_u16_d16_hi v146, v21 offset:768
    ds_read_u16_d16_hi v142, v20 offset:1280
    ds_read_u16_d16_hi v150, v21 offset:1792
    ds_read_u16_d16_hi v139, v20 offset:384
    ds_read_u16_d16_hi v147, v21 offset:896
    ds_read_u16_d16_hi v143, v20 offset:1408
    ds_read_u16_d16_hi v151, v21 offset:1920
    s_lshr_b32 s42, s39, 1
    s_lshl_b32 s42, s42, 4
    v_and_or_b32 v1, v5, 14, s42
    v_cmp_ne_u32 vcc, 0, v1
    v_mov_b32 v52, 0x3e800000
    v_cvt_f32_u32 v1, v1
    v_mul_f32 v1, 0x3a800000, v1
    v_cndmask_b32 v1, v52, v1, vcc
    v_cos_f32 v54, v1
    v_sin_f32 v55, v1
    v_mul_f32 v54, 0x35807fcc, v54
    v_mul_f32 v55, 0x35807fcc, v55
    v_cndmask_b32 v54, 0, v54, vcc
    v_sub_f32 v52, 0x35807fcc, v55
    v_add_f32 v53, 0x35807fcc, v55
    s_waitcnt lgkmcnt(11)
    v_pk_mul_f32 v[152:153], v[136:137], v[52:53] op_sel_hi:[1,0]
    v_pk_mul_f32 v[168:169], v[136:137], v[52:53] op_sel:[0,1] op_sel_hi:[1,1]
    s_waitcnt lgkmcnt(10)
    v_pk_add_f32 v[164:165], v[136:137], v[144:145] neg_lo:[0,1] neg_hi:[0,1]
    s_waitcnt lgkmcnt(9)
    v_pk_mul_f32 v[156:157], v[140:141], v[52:53] op_sel_hi:[1,0]
    v_pk_mul_f32 v[172:173], v[140:141], v[52:53] op_sel:[0,1] op_sel_hi:[1,1]
    s_waitcnt lgkmcnt(8)
    v_pk_add_f32 v[160:161], v[140:141], v[148:149]
    v_pk_fma_f32 v[152:153], v[144:145], v[52:53], v[152:153] op_sel:[0,1,0] op_sel_hi:[1,1,1]
    v_pk_fma_f32 v[168:169], v[144:145], v[52:53], v[168:169] op_sel_hi:[1,0,1]
    v_pk_mul_f32 v[164:165], v[164:165], v[54:55] op_sel_hi:[1,0]
    v_pk_fma_f32 v[156:157], v[148:149], v[52:53], v[156:157] op_sel:[0,1,0] op_sel_hi:[1,1,1] neg_lo:[0,1,0] neg_hi:[0,1,0]
    v_pk_fma_f32 v[172:173], v[148:149], v[52:53], v[172:173] op_sel_hi:[1,0,1] neg_lo:[0,1,0] neg_hi:[0,1,0]
    v_pk_mul_f32 v[160:161], v[160:161], v[54:55] op_sel_hi:[1,0] neg_lo:[0,1] neg_hi:[0,1]
    s_waitcnt lgkmcnt(3)
    v_pk_mul_f32 v[154:155], v[138:139], v[52:53] op_sel_hi:[1,0]
    v_pk_mul_f32 v[170:171], v[138:139], v[52:53] op_sel:[0,1] op_sel_hi:[1,1]
    s_waitcnt lgkmcnt(2)
    v_pk_add_f32 v[166:167], v[138:139], v[146:147] neg_lo:[0,1] neg_hi:[0,1]
    s_waitcnt lgkmcnt(1)
    v_pk_mul_f32 v[158:159], v[142:143], v[52:53] op_sel_hi:[1,0]
    v_pk_mul_f32 v[174:175], v[142:143], v[52:53] op_sel:[0,1] op_sel_hi:[1,1]
    s_waitcnt lgkmcnt(0)
    v_pk_add_f32 v[162:163], v[142:143], v[150:151]
    v_pk_fma_f32 v[154:155], v[146:147], v[52:53], v[154:155] op_sel:[0,1,0] op_sel_hi:[1,1,1]
    v_pk_fma_f32 v[170:171], v[146:147], v[52:53], v[170:171] op_sel_hi:[1,0,1]
    v_pk_mul_f32 v[166:167], v[166:167], v[54:55] op_sel_hi:[1,0]
    v_pk_fma_f32 v[158:159], v[150:151], v[52:53], v[158:159] op_sel:[0,1,0] op_sel_hi:[1,1,1] neg_lo:[0,1,0] neg_hi:[0,1,0]
    v_pk_fma_f32 v[174:175], v[150:151], v[52:53], v[174:175] op_sel_hi:[1,0,1] neg_lo:[0,1,0] neg_hi:[0,1,0]
    v_pk_mul_f32 v[162:163], v[162:163], v[54:55] op_sel_hi:[1,0] neg_lo:[0,1] neg_hi:[0,1]
    s_waitcnt vmcnt(15)
    v_xor_b32 v120, v61, v120
    s_waitcnt vmcnt(14)
    v_xor_b32 v121, v61, v121
    s_waitcnt vmcnt(13)
    v_xor_b32 v122, v61, v122
    s_waitcnt vmcnt(12)
    v_xor_b32 v123, v61, v123
    v_or_b32 v1, v120, v121
    v_or3_b32 v1, v1, v122, v123
    v_mfma_f32_16x16x32_f16 v[136:139], v[88:91], v[120:123], 0
    s_waitcnt vmcnt(11)
    v_xor_b32 v124, v61, v124
    s_waitcnt vmcnt(10)
    v_xor_b32 v125, v61, v125
    s_waitcnt vmcnt(9)
    v_xor_b32 v126, v61, v126
    s_waitcnt vmcnt(8)
    v_xor_b32 v127, v61, v127
    v_or3_b32 v1, v1, v124, v125
    v_or3_b32 v1, v1, v126, v127
    v_mfma_f32_16x16x32_f16 v[140:143], v[92:95], v[124:127], 0
    s_waitcnt vmcnt(7)
    v_xor_b32 v128, v61, v128
    s_waitcnt vmcnt(6)
    v_xor_b32 v129, v61, v129
    s_waitcnt vmcnt(5)
    v_xor_b32 v130, v61, v130
    s_waitcnt vmcnt(4)
    v_xor_b32 v131, v61, v131
    v_or3_b32 v1, v1, v128, v129
    v_or3_b32 v1, v1, v130, v131
    v_mfma_f32_16x16x32_f16 v[144:147], v[96:99], v[128:131], 0
    s_waitcnt vmcnt(3)
    v_xor_b32 v132, v61, v132
    s_waitcnt vmcnt(2)
    v_xor_b32 v133, v61, v133
    s_waitcnt vmcnt(1)
    v_xor_b32 v134, v61, v134
    s_waitcnt vmcnt(0)
    v_xor_b32 v135, v61, v135
    v_or3_b32 v1, v1, v132, v133
    v_or3_b32 v1, v1, v134, v135
    v_mfma_f32_16x16x32_f16 v[148:151], v[100:103], v[132:135], 0
    v_and_b32 v1, s46, v1
    v_cmp_ne_u32 vcc, 0, v1
    s_cbranch_vccnz L_z1_retry_2
L_z1_ok_3:
    v_cvt_pk_f16_f32 v176, v136, v137
    v_cvt_pk_f16_f32 v177, v140, v141
    v_cvt_pk_f16_f32 v178, v144, v145
    s_nop 1
    v_cvt_pk_f16_f32 v179, v148, v149
    ds_write_b128 v9, v[176:179] offset:0
    v_cvt_pk_f16_f32 v180, v138, v139
    v_cvt_pk_f16_f32 v181, v142, v143
    v_cvt_pk_f16_f32 v182, v146, v147
    v_cvt_pk_f16_f32 v183, v150, v151
    ds_write_b128 v9, v[180:183] offset:128
    s_waitcnt lgkmcnt(0)
    s_barrier
    ds_read_b128 v[120:123], v10 offset:0
    ds_read_b128 v[124:127], v10 offset:256
    v_mov_b32 v1, s47
    buffer_store_dword v1, v3, s[32:35], s64 offen sc1
    s_waitcnt lgkmcnt(1)
    v_mfma_f32_16x16x32_f16 v[136:139], v[36:39], v[120:123], 0
    v_mfma_f32_16x16x32_f16 v[140:143], v[40:43], v[120:123], 0
    s_waitcnt lgkmcnt(0)
    v_mfma_f32_16x16x32_f16 v[144:147], v[36:39], v[124:127], 0
    v_mfma_f32_16x16x32_f16 v[148:151], v[40:43], v[124:127], 0
    s_nop 3
    v_pk_mul_f32 v[176:177], v[136:137], v[152:153]
    v_pk_mul_f32 v[178:179], v[138:139], v[154:155]
    v_pk_mul_f32 v[180:181], v[136:137], v[156:157]
    v_pk_mul_f32 v[182:183], v[138:139], v[158:159]
    v_pk_mul_f32 v[184:185], v[136:137], v[160:161] neg_lo:[0,1] neg_hi:[0,1]
    v_pk_mul_f32 v[186:187], v[138:139], v[162:163] neg_lo:[0,1] neg_hi:[0,1]
    v_pk_mul_f32 v[188:189], v[136:137], v[164:165] neg_lo:[0,1] neg_hi:[0,1]
    v_pk_mul_f32 v[190:191], v[138:139], v[166:167] neg_lo:[0,1] neg_hi:[0,1]
    v_pk_fma_f32 v[176:177], v[140:141], v[156:157], v[176:177] neg_lo:[0,1,0] neg_hi:[0,1,0]
    v_pk_fma_f32 v[178:179], v[142:143], v[158:159], v[178:179] neg_lo:[0,1,0] neg_hi:[0,1,0]
    v_pk_fma_f32 v[180:181], v[140:141], v[152:153], v[180:181]
    v_pk_fma_f32 v[182:183], v[142:143], v[154:155], v[182:183]
    v_pk_fma_f32 v[184:185], v[140:141], v[164:165], v[184:185]
    v_pk_fma_f32 v[186:187], v[142:143], v[166:167], v[186:187]
    v_pk_fma_f32 v[188:189], v[140:141], v[160:161], v[188:189] neg_lo:[0,1,0] neg_hi:[0,1,0]
    v_pk_fma_f32 v[190:191], v[142:143], v[162:163], v[190:191] neg_lo:[0,1,0] neg_hi:[0,1,0]
    v_pk_fma_f32 v[176:177], v[144:145], v[160:161], v[176:177]
    v_pk_fma_f32 v[178:179], v[146:147], v[162:163], v[178:179]
    v_pk_fma_f32 v[180:181], v[144:145], v[164:165], v[180:181]
    v_pk_fma_f32 v[182:183], v[146:147], v[166:167], v[182:183]
    v_pk_fma_f32 v[176:177], v[148:149], v[164:165], v[176:177] neg_lo:[0,1,0] neg_hi:[0,1,0]
    v_pk_fma_f32 v[178:179], v[150:151], v[166:167], v[178:179] neg_lo:[0,1,0] neg_hi:[0,1,0]
    v_pk_fma_f32 v[180:181], v[148:149], v[160:161], v[180:181]
    v_pk_fma_f32 v[182:183], v[150:151], v[162:163], v[182:183]
    v_cvt_pk_bf16_f32 v120, v180, v176
    v_cvt_pk_bf16_f32 v121, v181, v177
    v_cvt_pk_bf16_f32 v122, v182, v178
    v_cvt_pk_bf16_f32 v123, v183, v179
    s_nop 1
    v_mfma_f32_16x16x32_bf16 v[128:131], v[120:123], v[32:35], 0
    v_mfma_f32_16x16x32_bf16 v[132:135], v[120:123], v[28:31], 0
    v_pk_fma_f32 v[184:185], v[144:145], v[168:169], v[184:185]
    v_pk_fma_f32 v[186:187], v[146:147], v[170:171], v[186:187]
    v_pk_fma_f32 v[188:189], v[144:145], v[172:173], v[188:189]
    v_pk_fma_f32 v[190:191], v[146:147], v[174:175], v[190:191]
    v_pk_fma_f32 v[184:185], v[148:149], v[172:173], v[184:185] neg_lo:[0,1,0] neg_hi:[0,1,0]
    v_pk_fma_f32 v[186:187], v[150:151], v[174:175], v[186:187] neg_lo:[0,1,0] neg_hi:[0,1,0]
    v_pk_fma_f32 v[188:189], v[148:149], v[168:169], v[188:189]
    v_pk_fma_f32 v[190:191], v[150:151], v[170:171], v[190:191]
    v_cvt_pk_bf16_f32 v124, v188, v184
    v_cvt_pk_bf16_f32 v125, v189, v185
    v_cvt_pk_bf16_f32 v126, v190, v186
    v_cvt_pk_bf16_f32 v127, v191, v187
    s_nop 1
    v_mfma_f32_16x16x32_bf16 v[136:139], v[124:127], v[32:35], 0
    v_mfma_f32_16x16x32_bf16 v[140:143], v[124:127], v[28:31], 0
    v_cvt_pk_bf16_f32 v176, v128, v132
    v_cvt_pk_bf16_f32 v177, v129, v133
    ds_write_b64 v11, v[176:177] offset:0
    v_cvt_pk_bf16_f32 v178, v130, v134
    v_cvt_pk_bf16_f32 v179, v131, v135
    ds_write_b64 v11, v[178:179] offset:16
    s_nop 1
    v_cvt_pk_bf16_f32 v180, v136, v140
    v_cvt_pk_bf16_f32 v181, v137, v141
    ds_write_b64 v11, v[180:181] offset:128
    v_cvt_pk_bf16_f32 v182, v138, v142
    v_cvt_pk_bf16_f32 v183, v139, v143
    ds_write_b64 v11, v[182:183] offset:144
    s_mov_b32 s46, 0x10001
    s_waitcnt lgkmcnt(0)
    s_barrier
    ds_read_b128 v[120:123], v17 offset:0
    ds_read_b128 v[124:127], v17 offset:1056
    s_waitcnt lgkmcnt(1)
    v_mfma_f32_16x16x32_bf16 v[136:139], v[120:123], v[104:107], 0
    v_mfma_f32_16x16x32_bf16 v[140:143], v[120:123], v[108:111], 0
    s_waitcnt lgkmcnt(0)
    v_mfma_f32_16x16x32_bf16 v[144:147], v[124:127], v[112:115], 0
    v_mfma_f32_16x16x32_bf16 v[148:151], v[124:127], v[116:119], 0
    s_nop 4
    v_cvt_pk_bf16_f32 v176, v136, v140
    v_cvt_pk_bf16_f32 v177, v137, v141
    v_cvt_pk_bf16_f32 v178, v138, v142
    v_cvt_pk_bf16_f32 v179, v139, v143
    v_bfi_b32 v176, s46, v22, v176
    v_bfi_b32 v177, s46, v23, v177
    v_bfi_b32 v178, s46, v24, v178
    v_bfi_b32 v179, s46, v25, v179
    buffer_store_dwordx4 v[176:179], v18, s[32:35], s62 offen sc1
    v_cvt_pk_bf16_f32 v180, v144, v148
    v_cvt_pk_bf16_f32 v181, v145, v149
    v_cvt_pk_bf16_f32 v182, v146, v150
    v_cvt_pk_bf16_f32 v183, v147, v151
    v_bfi_b32 v180, s46, v22, v180
    v_bfi_b32 v181, s46, v23, v181
    v_bfi_b32 v182, s46, v24, v182
    v_bfi_b32 v183, s46, v25, v183
    buffer_store_dwordx4 v[180:183], v18, s[32:35], s63 offen sc1
    v_lshlrev_b32 v7, 6, v5
    v_lshl_add_u32 v7, v6, 4, v7
    buffer_load_dwordx4 v[18:21], v7, s[8:11], s56 offen
    buffer_load_dwordx4 v[22:25], v7, s[8:11], s57 offen
    s_bfe_u32 s42, s37, 0x60001
    s_lshl_b32 s42, s42, 15
    s_lshl_b32 s43, s36, 13
    s_add_u32 s42, s42, s43
    s_and_b32 s43, s39, 1
    s_lshl_b32 s43, s43, 6
    s_add_u32 s42, s42, s43
    s_add_u32 s60, s42, 2097152
    s_add_u32 s61, s42, 2101248
    v_lshrrev_b32 v62, 1, v5
    v_lshl_add_u32 v62, v62, 8, s37
    v_and_b32 v1, 1, v6
    v_mul_u32_u24 v17, v62, v1
    s_lshr_b32 s42, s37, 4
    s_lshl_b32 s42, s42, 4
    v_and_b32 v60, 2, v6
    v_mad_u32_u24 v17, v60, s42, v17
    v_and_b32 v1, 1, v5
    v_lshlrev_b32 v1, 7, v1
    v_sub_u32 v17, v1, v17
    v_and_b32 v17, 511, v17
    v_cvt_f32_u32 v62, v62
    v_cvt_f32_u32 v17, v17
    v_lshlrev_b32 v60, 14, v60
    v_mul_f32 v17, 0x3b000000, v17
    v_xor_b32 v36, v60, v28
    v_xor_b32 v37, v60, v29
    v_xor_b32 v38, v60, v30
    v_xor_b32 v39, v60, v31
    v_xor_b32 v40, v60, v32
    v_xor_b32 v41, v60, v33
    v_xor_b32 v42, v60, v34
    v_xor_b32 v43, v60, v35
    v_cos_f32 v60, v17
    v_sin_f32 v61, v17
    v_fmamk_f32 v17, v62, 0xba000000, v17
    v_cvt_pk_bf16_f32 v52, v60, v61
    v_cos_f32 v60, v17
    v_sin_f32 v61, v17
    v_fmamk_f32 v17, v62, 0xba000000, v17
    v_cvt_pk_bf16_f32 v53, v60, v61
    v_cos_f32 v60, v17
    v_sin_f32 v61, v17
    v_fmamk_f32 v17, v62, 0xba000000, v17
    v_cvt_pk_bf16_f32 v54, v60, v61
    v_cos_f32 v60, v17
    v_sin_f32 v61, v17
    s_nop 0
    v_cvt_pk_bf16_f32 v55, v60, v61
    v_mul_u32_u24 v62, 16192, v6
    v_add_u32 v62, 99328, v62
    s_lshl_b32 s42, s36, 5
    v_and_or_b32 v17, v5, 7, s42
    v_cmp_lt_u32 s[4:5], 7, v5
    v_cmp_eq_u32 vcc, 0, v17
    v_sub_u32 v60, 256, v17
    v_mov_b32 v1, 128
    v_cndmask_b32 v1, v60, v1, vcc
    v_cndmask_b32 v56, v17, v1, s[4:5]
    v_lshrrev_b32 v1, 6, v56
    v_lshl_add_u32 v56, v1, 4, v56
    v_lshl_add_u32 v56, v56, 2, v62
    v_add_u32 v17, 8, v17
    v_add_u32 v60, -8, v60
    v_cndmask_b32 v57, v17, v60, s[4:5]
    v_lshrrev_b32 v1, 6, v57
    v_lshl_add_u32 v57, v1, 4, v57
    v_lshl_add_u32 v57, v57, 2, v62
    v_add_u32 v17, 8, v17
    v_add_u32 v60, -8, v60
    v_cndmask_b32 v58, v17, v60, s[4:5]
    v_lshrrev_b32 v1, 6, v58
    v_lshl_add_u32 v58, v1, 4, v58
    v_lshl_add_u32 v58, v58, 2, v62
    v_add_u32 v17, 8, v17
    v_add_u32 v60, -8, v60
    v_cndmask_b32 v59, v17, v60, s[4:5]
    v_lshrrev_b32 v1, 6, v59
    v_lshl_add_u32 v59, v1, 4, v59
    v_lshl_add_u32 v59, v59, 2, v62
    s_mul_i32 s42, s36, 16192
    s_add_u32 s42, s42, 99328
    v_mul_u32_u24 v17, 320, v6
    v_lshl_add_u32 v17, v5, 2, v17
    v_add_u32 v10, s42, v17
    v_add_u32 v11, 1280, v10
    v_mov_b32 v66, 0
    v_mov_b32 v67, 0
    v_mov_b32 v68, 0
    v_mov_b32 v69, 0
    v_mov_b32 v9, 0x36a1369a
    s_add_u32 s62, s55, 4194304
    s_lshr_b32 s63, s55, 4
    s_add_u32 s63, s63, 6291456
    s_mul_i32 s54, s36, 4160
    v_xor_b32 v1, s41, v4
    v_lshlrev_b32 v16, 4, v1
    s_lshr_b32 s42, s50, 3
    s_lshl_b32 s42, s42, 12
    s_lshl_b32 s43, s36, 8
    s_add_u32 s42, s42, s43
    s_add_u32 s42, s42, 6291464
    v_and_b32 v1, 3, v5
    v_lshl_add_u32 v1, v1, 6, s42
    v_lshl_add_u32 v15, v6, 10, v1
    s_lshr_b32 s52, s50, 3
    s_mul_i32 s52, s52, 180224
    s_add_u32 s52, s52, 8388608
    s_lshl_b32 s42, s36, 12
    s_add_u32 s42, s42, 66560
    v_bitop3_b32 v1, v5, v6, 7 bitop3:0x28
    v_lshl_add_u32 v1, v1, 4, s42
    v_lshl_add_u32 v13, v5, 8, v1
    v_xor_b32 v14, 64, v13
    s_lshr_b32 s44, s39, 3
    s_mul_i32 s44, s44, 0
    s_mul_i32 s43, s38, 7
    s_add_u32 s44, s44, s43
    s_mul_i32 s43, s44, 373
    s_lshr_b32 s43, s43, 12
    s_mul_i32 s43, s43, 11
    s_sub_u32 s44, s44, s43
    s_lshl_b32 s44, s44, 10
    s_mul_i32 s43, s36, 11264
    s_add_u32 s42, s44, s43
    s_add_u32 s44, s43, 11264
    s_cmp_eq_u32 s42, 44032
    s_cselect_b32 s68, 0x2000000, s42
    s_add_u32 s42, s42, 1024
    s_cmp_eq_u32 s42, s44
    s_cselect_b32 s42, s43, s42
    s_cmp_eq_u32 s42, 44032
    s_cselect_b32 s69, 0x2000000, s42
    s_add_u32 s42, s42, 1024
    s_cmp_eq_u32 s42, s44
    s_cselect_b32 s42, s43, s42
    s_cmp_eq_u32 s42, 44032
    s_cselect_b32 s70, 0x2000000, s42
    s_add_u32 s42, s42, 1024
    s_cmp_eq_u32 s42, s44
    s_cselect_b32 s42, s43, s42
    s_cmp_eq_u32 s42, 44032
    s_cselect_b32 s71, 0x2000000, s42
    s_add_u32 s42, s42, 1024
    s_cmp_eq_u32 s42, s44
    s_cselect_b32 s42, s43, s42
    s_cmp_eq_u32 s42, 44032
    s_cselect_b32 s72, 0x2000000, s42
    s_add_u32 s42, s42, 1024
    s_cmp_eq_u32 s42, s44
    s_cselect_b32 s42, s43, s42
    s_cmp_eq_u32 s42, 44032
    s_cselect_b32 s73, 0x2000000, s42
    s_add_u32 s42, s42, 1024
    s_cmp_eq_u32 s42, s44
    s_cselect_b32 s42, s43, s42
    s_cmp_eq_u32 s42, 44032
    s_cselect_b32 s74, 0x2000000, s42
    s_add_u32 s42, s42, 1024
    s_cmp_eq_u32 s42, s44
    s_cselect_b32 s42, s43, s42
    s_cmp_eq_u32 s42, 44032
    s_cselect_b32 s75, 0x2000000, s42
    s_add_u32 s42, s42, 1024
    s_cmp_eq_u32 s42, s44
    s_cselect_b32 s42, s43, s42
    s_cmp_eq_u32 s42, 44032
    s_cselect_b32 s76, 0x2000000, s42
    s_add_u32 s42, s42, 1024
    s_cmp_eq_u32 s42, s44
    s_cselect_b32 s42, s43, s42
    s_cmp_eq_u32 s42, 44032
    s_cselect_b32 s77, 0x2000000, s42
    s_add_u32 s42, s42, 1024
    s_cmp_eq_u32 s42, s44
    s_cselect_b32 s42, s43, s42
    s_cmp_eq_u32 s42, 44032
    s_cselect_b32 s78, 0x2000000, s42
    s_mul_i32 s53, s40, 176128
    s_add_u32 s53, s53, 18874368
    s_sleep 6
    buffer_load_dword v74, v8, s[32:35], s60 offen offset:0 sc1
    buffer_load_dword v75, v8, s[32:35], s60 offen offset:128 sc1
    buffer_load_dword v76, v8, s[32:35], s60 offen offset:256 sc1
    buffer_load_dword v77, v8, s[32:35], s60 offen offset:384 sc1
    buffer_load_dword v78, v8, s[32:35], s60 offen offset:2048 sc1
    buffer_load_dword v79, v8, s[32:35], s60 offen offset:2176 sc1
    buffer_load_dword v80, v8, s[32:35], s60 offen offset:2304 sc1
    buffer_load_dword v81, v8, s[32:35], s60 offen offset:2432 sc1
    buffer_load_dword v82, v8, s[32:35], s61 offen offset:0 sc1
    buffer_load_dword v83, v8, s[32:35], s61 offen offset:128 sc1
    buffer_load_dword v84, v8, s[32:35], s61 offen offset:256 sc1
    buffer_load_dword v85, v8, s[32:35], s61 offen offset:384 sc1
    buffer_load_dword v86, v8, s[32:35], s61 offen offset:2048 sc1
    buffer_load_dword v87, v8, s[32:35], s61 offen offset:2176 sc1
    buffer_load_dword v88, v8, s[32:35], s61 offen offset:2304 sc1
    buffer_load_dword v89, v8, s[32:35], s61 offen offset:2432 sc1
    s_barrier
    v_not_b32 v60, s47
    v_lshlrev_b32 v1, 2, v4
    s_mov_b32 exec_hi, 0
    buffer_store_dword v60, v1, s[32:35], s63 offen sc1
    s_mov_b32 exec_hi, -1
    s_waitcnt vmcnt(18)
    v_lshlrev_b32 v90, 16, v18
    v_and_b32 v94, 0xffff0000, v18
    v_lshlrev_b32 v91, 16, v19
    v_and_b32 v95, 0xffff0000, v19
    v_lshlrev_b32 v92, 16, v20
    v_and_b32 v96, 0xffff0000, v20
    v_lshlrev_b32 v93, 16, v21
    v_and_b32 v97, 0xffff0000, v21
    s_waitcnt vmcnt(17)
    v_lshlrev_b32 v98, 16, v22
    v_and_b32 v102, 0xffff0000, v22
    v_lshlrev_b32 v99, 16, v23
    v_and_b32 v103, 0xffff0000, v23
    v_lshlrev_b32 v100, 16, v24
    v_and_b32 v104, 0xffff0000, v24
    v_lshlrev_b32 v101, 16, v25
    v_and_b32 v105, 0xffff0000, v25
    s_lshr_b32 s42, s50, 3
    s_lshl_b32 s43, s42, 16
    s_lshl_b32 s44, s36, 12
    s_add_u32 s42, s43, s44
    s_add_u32 s64, s42, 4194304
    s_add_u32 s65, s42, 4210688
    s_add_u32 s66, s42, 4227072
    s_add_u32 s67, s42, 4243456
    s_waitcnt vmcnt(16)
    v_xor_b32 v74, v26, v74
    s_waitcnt vmcnt(15)
    v_xor_b32 v75, v26, v75
    s_waitcnt vmcnt(14)
    v_xor_b32 v76, v26, v76
    s_waitcnt vmcnt(13)
    v_xor_b32 v77, v26, v77
    v_or_b32 v1, v74, v75
    v_or3_b32 v1, v1, v76, v77
    v_mfma_f32_16x16x32_bf16 v[106:109], v[52:55], v[74:77], 0
    s_waitcnt vmcnt(12)
    v_xor_b32 v78, v26, v78
    s_waitcnt vmcnt(11)
    v_xor_b32 v79, v26, v79
    s_waitcnt vmcnt(10)
    v_xor_b32 v80, v26, v80
    s_waitcnt vmcnt(9)
    v_xor_b32 v81, v26, v81
    v_or3_b32 v1, v1, v78, v79
    v_or3_b32 v1, v1, v80, v81
    v_mfma_f32_16x16x32_bf16 v[110:113], v[52:55], v[78:81], 0
    s_waitcnt vmcnt(8)
    v_xor_b32 v82, v26, v82
    s_waitcnt vmcnt(7)
    v_xor_b32 v83, v26, v83
    s_waitcnt vmcnt(6)
    v_xor_b32 v84, v26, v84
    s_waitcnt vmcnt(5)
    v_xor_b32 v85, v26, v85
    v_or3_b32 v1, v1, v82, v83
    v_or3_b32 v1, v1, v84, v85
    v_mfma_f32_16x16x32_bf16 v[114:117], v[52:55], v[82:85], 0
    s_waitcnt vmcnt(4)
    v_xor_b32 v86, v26, v86
    s_waitcnt vmcnt(3)
    v_xor_b32 v87, v26, v87
    s_waitcnt vmcnt(2)
    v_xor_b32 v88, v26, v88
    s_waitcnt vmcnt(1)
    v_xor_b32 v89, v26, v89
    v_or3_b32 v1, v1, v86, v87
    v_or3_b32 v1, v1, v88, v89
    v_mfma_f32_16x16x32_bf16 v[118:121], v[52:55], v[86:89], 0
    v_and_b32 v1, s46, v1
    v_cmp_ne_u32 vcc, 0, v1
    s_cbranch_vccnz L_z2_retry_4
L_z2_ok_5:
    v_cvt_pk_bf16_f32 v122, v107, v106
    v_cvt_pk_bf16_f32 v123, v109, v108
    ds_write2st64_b32 v56, v122, v123 offset0:0 offset1:5
    v_cvt_pk_bf16_f32 v124, v111, v110
    v_cvt_pk_bf16_f32 v125, v113, v112
    ds_write2st64_b32 v57, v124, v125 offset0:0 offset1:5
    v_cvt_pk_bf16_f32 v126, v115, v114
    v_cvt_pk_bf16_f32 v127, v117, v116
    ds_write2st64_b32 v58, v126, v127 offset0:0 offset1:5
    v_cvt_pk_bf16_f32 v128, v119, v118
    v_cvt_pk_bf16_f32 v129, v121, v120
    ds_write2st64_b32 v59, v128, v129 offset0:0 offset1:5
    s_waitcnt lgkmcnt(0)
    s_barrier
    ds_read2_b32 v[74:75], v10 offset0:0 offset1:16
    ds_read2_b32 v[76:77], v10 offset0:32 offset1:48
    ds_read2_b32 v[78:79], v11 offset0:0 offset1:16
    ds_read2_b32 v[80:81], v11 offset0:32 offset1:48
    s_waitcnt lgkmcnt(2)
    v_mfma_f32_16x16x32_bf16 v[106:109], v[74:77], v[40:43], 0
    v_mfma_f32_16x16x32_bf16 v[110:113], v[74:77], v[36:39], 0
    s_waitcnt lgkmcnt(0)
    v_mfma_f32_16x16x32_bf16 v[114:117], v[78:81], v[40:43], 0
    v_mfma_f32_16x16x32_bf16 v[118:121], v[78:81], v[36:39], 0
    s_nop 3
    v_pk_mul_f32 v[122:123], v[106:107], v[44:45]
    v_pk_mul_f32 v[126:127], v[110:111], v[44:45]
    v_pk_mul_f32 v[124:125], v[108:109], v[46:47]
    v_pk_mul_f32 v[128:129], v[112:113], v[46:47]
    v_pk_fma_f32 v[122:123], v[110:111], v[48:49], v[122:123] neg_lo:[0,1,0] neg_hi:[0,1,0]
    v_pk_fma_f32 v[126:127], v[106:107], v[48:49], v[126:127]
    v_pk_fma_f32 v[124:125], v[112:113], v[50:51], v[124:125] neg_lo:[0,1,0] neg_hi:[0,1,0]
    v_pk_fma_f32 v[128:129], v[108:109], v[50:51], v[128:129]
    v_cvt_pk_bf16_f32 v74, v126, v122
    v_cvt_pk_bf16_f32 v75, v127, v123
    v_cvt_pk_bf16_f32 v76, v128, v124
    v_cvt_pk_bf16_f32 v77, v129, v125
    s_nop 1
    v_mfma_f32_16x16x32_bf16 v[90:93], v[74:77], v[32:35], v[90:93]
    v_mfma_f32_16x16x32_bf16 v[94:97], v[74:77], v[28:31], v[94:97]
    v_pk_mul_f32 v[130:131], v[114:115], v[44:45]
    v_pk_mul_f32 v[134:135], v[118:119], v[44:45]
    v_pk_mul_f32 v[132:133], v[116:117], v[46:47]
    v_pk_mul_f32 v[136:137], v[120:121], v[46:47]
    v_pk_fma_f32 v[130:131], v[118:119], v[48:49], v[130:131] neg_lo:[0,1,0] neg_hi:[0,1,0]
    v_pk_fma_f32 v[134:135], v[114:115], v[48:49], v[134:135]
    v_pk_fma_f32 v[132:133], v[120:121], v[50:51], v[132:133] neg_lo:[0,1,0] neg_hi:[0,1,0]
    v_pk_fma_f32 v[136:137], v[116:117], v[50:51], v[136:137]
    v_cvt_pk_bf16_f32 v78, v134, v130
    v_cvt_pk_bf16_f32 v79, v135, v131
    v_cvt_pk_bf16_f32 v80, v136, v132
    v_cvt_pk_bf16_f32 v81, v137, v133
    s_nop 1
    v_mfma_f32_16x16x32_bf16 v[98:101], v[78:81], v[32:35], v[98:101]
    v_mfma_f32_16x16x32_bf16 v[102:105], v[78:81], v[28:31], v[102:105]
    v_cvt_pk_bf16_f32 v106, v90, v94
    v_cvt_pk_bf16_f32 v107, v91, v95
    v_cvt_pk_bf16_f32 v108, v92, v96
    v_cvt_pk_bf16_f32 v109, v93, v97
    v_dot2c_f32_bf16 v66, s45, v106
    v_dot2c_f32_bf16 v68, v106, v106
    v_dot2c_f32_bf16 v66, s45, v107
    v_dot2c_f32_bf16 v68, v107, v107
    v_dot2c_f32_bf16 v66, s45, v108
    v_dot2c_f32_bf16 v68, v108, v108
    v_dot2c_f32_bf16 v66, s45, v109
    v_dot2c_f32_bf16 v68, v109, v109
    v_cvt_pk_bf16_f32 v110, v98, v102
    v_cvt_pk_bf16_f32 v111, v99, v103
    v_cvt_pk_bf16_f32 v112, v100, v104
    v_cvt_pk_bf16_f32 v113, v101, v105
    v_dot2c_f32_bf16 v67, s45, v110
    v_dot2c_f32_bf16 v69, v110, v110
    v_dot2c_f32_bf16 v67, s45, v111
    v_dot2c_f32_bf16 v69, v111, v111
    v_dot2c_f32_bf16 v67, s45, v112
    v_dot2c_f32_bf16 v69, v112, v112
    v_dot2c_f32_bf16 v67, s45, v113
    v_dot2c_f32_bf16 v69, v113, v113
    s_nop 1
    v_permlane32_swap_b32 v66, v67
    v_permlane32_swap_b32 v68, v69
    v_add_f32 v66, v66, v67
    v_add_f32 v68, v68, v69
    s_nop 1
    v_permlane16_swap_b32 v66, v68
    v_add_f32 v66, v66, v68
    s_nop 1
    v_add_f32_dpp v66, v66, v66 row_ror:8 row_mask:0xf bank_mask:0xf
    s_nop 1
    v_add_f32_dpp v66, v66, v66 row_ror:4 row_mask:0xf bank_mask:0xf
    s_nop 1
    v_add_f32_dpp v66, v66, v66 row_ror:2 row_mask:0xf bank_mask:0xf
    s_nop 1
    v_add_f32_dpp v66, v66, v66 row_ror:1 row_mask:0xf bank_mask:0xf
    v_mul_f32 v68, 0x3b000000, v66
    v_mul_f32 v66, 0x3b000000, v66
    s_nop 1
    v_permlane16_swap_b32 v66, v68
    v_fma_f32 v68, -v66, v66, v68
    v_max_f32 v68, 0, v68
    v_fmamk_f32 v68, v68, 0x3ef5fdf0, v9
    v_rsq_f32 v68, v68
    s_nop 0
    v_mul_f32 v70, v66, v68
    v_mul_f32 v72, v66, v68
    v_mov_b32 v66, v68
    s_nop 0
    v_permlane32_swap_b32 v70, v72
    v_permlane32_swap_b32 v66, v68
    v_pk_fma_f32 v[90:91], v[90:91], v[66:67], v[70:71] op_sel_hi:[1,0,0] neg_lo:[0,0,1] neg_hi:[0,0,1]
    v_pk_fma_f32 v[92:93], v[92:93], v[66:67], v[70:71] op_sel_hi:[1,0,0] neg_lo:[0,0,1] neg_hi:[0,0,1]
    v_pk_fma_f32 v[94:95], v[94:95], v[66:67], v[70:71] op_sel_hi:[1,0,0] neg_lo:[0,0,1] neg_hi:[0,0,1]
    v_pk_fma_f32 v[96:97], v[96:97], v[66:67], v[70:71] op_sel_hi:[1,0,0] neg_lo:[0,0,1] neg_hi:[0,0,1]
    v_cvt_pk_bf16_f32 v122, v90, v94
    v_cvt_pk_bf16_f32 v123, v91, v95
    v_cvt_pk_bf16_f32 v124, v92, v96
    v_cvt_pk_bf16_f32 v125, v93, v97
    buffer_store_dwordx4 v[122:125], v7, s[32:35], s62 offen offset:0 sc1
    v_pk_fma_f32 v[98:99], v[98:99], v[68:69], v[72:73] op_sel_hi:[1,0,0] neg_lo:[0,0,1] neg_hi:[0,0,1]
    v_pk_fma_f32 v[100:101], v[100:101], v[68:69], v[72:73] op_sel_hi:[1,0,0] neg_lo:[0,0,1] neg_hi:[0,0,1]
    v_pk_fma_f32 v[102:103], v[102:103], v[68:69], v[72:73] op_sel_hi:[1,0,0] neg_lo:[0,0,1] neg_hi:[0,0,1]
    v_pk_fma_f32 v[104:105], v[104:105], v[68:69], v[72:73] op_sel_hi:[1,0,0] neg_lo:[0,0,1] neg_hi:[0,0,1]
    v_cvt_pk_bf16_f32 v126, v98, v102
    v_cvt_pk_bf16_f32 v127, v99, v103
    v_cvt_pk_bf16_f32 v128, v100, v104
    v_cvt_pk_bf16_f32 v129, v101, v105
    buffer_store_dwordx4 v[126:129], v7, s[32:35], s62 offen offset:1024 sc1
    s_barrier
    v_cmp_gt_u32 vcc, 32, v4
    v_and_b32 v1, 28, v4
    v_mov_b32 v108, s47
    v_cndmask_b32 v106, v68, v66, vcc
    v_mov_b32 v107, v27
    v_rcp_f32 v106, v106
    v_lshlrev_b32 v1, 25, v1
    v_and_or_b32 v1, v2, 48, v1
    v_and_b32 v109, 32, v4
    v_lshl_add_u32 v1, v109, 1, v1
    s_waitcnt vmcnt(0)
    buffer_store_dwordx4 v[106:109], v1, s[32:35], s63 offen sc1
    s_sleep 24
    buffer_load_dword v8, v15, s[32:35], 0 offen sc1
    s_waitcnt vmcnt(0)
    v_cmp_ne_u32 vcc, s47, v8
    s_cbranch_vccnz L_hn_retry_6
L_hn_ok_7:
    s_add_u32 m0, s54, 0
    s_nop 0
    buffer_load_dwordx4 v16, s[32:35], s64 offen offset:0 sc1 lds
    s_add_u32 m0, s54, 16
    s_nop 0
    buffer_load_dwordx4 v16, s[32:35], s64 offen offset:1024 sc1 lds
    s_add_u32 m0, s54, 32
    s_nop 0
    buffer_load_dwordx4 v16, s[32:35], s64 offen offset:2048 sc1 lds
    s_add_u32 m0, s54, 48
    s_nop 0
    buffer_load_dwordx4 v16, s[32:35], s64 offen offset:3072 sc1 lds
    s_add_u32 m0, s54, 16640
    s_nop 0
    buffer_load_dwordx4 v16, s[32:35], s65 offen offset:0 sc1 lds
    s_add_u32 m0, s54, 16656
    s_nop 0
    buffer_load_dwordx4 v16, s[32:35], s65 offen offset:1024 sc1 lds
    s_add_u32 m0, s54, 16672
    s_nop 0
    buffer_load_dwordx4 v16, s[32:35], s65 offen offset:2048 sc1 lds
    s_add_u32 m0, s54, 16688
    s_nop 0
    buffer_load_dwordx4 v16, s[32:35], s65 offen offset:3072 sc1 lds
    s_add_u32 m0, s54, 33280
    s_nop 0
    buffer_load_dwordx4 v16, s[32:35], s66 offen offset:0 sc1 lds
    s_add_u32 m0, s54, 33296
    s_nop 0
    buffer_load_dwordx4 v16, s[32:35], s66 offen offset:1024 sc1 lds
    s_add_u32 m0, s54, 33312
    s_nop 0
    buffer_load_dwordx4 v16, s[32:35], s66 offen offset:2048 sc1 lds
    s_add_u32 m0, s54, 33328
    s_nop 0
    buffer_load_dwordx4 v16, s[32:35], s66 offen offset:3072 sc1 lds
    s_add_u32 m0, s54, 49920
    s_nop 0
    buffer_load_dwordx4 v16, s[32:35], s67 offen offset:0 sc1 lds
    s_add_u32 m0, s54, 49936
    s_nop 0
    buffer_load_dwordx4 v16, s[32:35], s67 offen offset:1024 sc1 lds
    s_add_u32 m0, s54, 49952
    s_nop 0
    buffer_load_dwordx4 v16, s[32:35], s67 offen offset:2048 sc1 lds
    s_add_u32 m0, s54, 49968
    s_nop 0
    buffer_load_dwordx4 v16, s[32:35], s67 offen offset:3072 sc1 lds
    s_waitcnt vmcnt(12)
    s_barrier
    s_setprio 1
    s_lshl2_add_u32 s51, s68, s53
    buffer_load_dwordx4 v[80:83], v2, s[32:35], s51 offen offset:0 sc1
    buffer_load_dwordx4 v[84:87], v2, s[32:35], s51 offen offset:1024 sc1
    buffer_load_dwordx4 v[88:91], v2, s[32:35], s51 offen offset:2048 sc1
    buffer_load_dwordx4 v[92:95], v2, s[32:35], s51 offen offset:3072 sc1
    s_lshl2_add_u32 s51, s69, s53
    buffer_load_dwordx4 v[96:99], v2, s[32:35], s51 offen offset:0 sc1
    buffer_load_dwordx4 v[100:103], v2, s[32:35], s51 offen offset:1024 sc1
    buffer_load_dwordx4 v[104:107], v2, s[32:35], s51 offen offset:2048 sc1
    buffer_load_dwordx4 v[108:111], v2, s[32:35], s51 offen offset:3072 sc1
    s_waitcnt vmcnt(16)
    s_waitcnt vmcnt(12)
    s_waitcnt vmcnt(8)
    s_barrier
    s_waitcnt vmcnt(6)
    s_lshl2_add_u32 s51, s70, s53
    buffer_load_dwordx4 v[112:115], v2, s[32:35], s51 offen offset:0 sc1
    buffer_load_dwordx4 v[116:119], v2, s[32:35], s51 offen offset:1024 sc1
    buffer_load_dwordx4 v[120:123], v2, s[32:35], s51 offen offset:2048 sc1
    buffer_load_dwordx4 v[124:127], v2, s[32:35], s51 offen offset:3072 sc1
    s_waitcnt vmcnt(6)
    s_lshl2_add_u32 s51, s71, s53
    buffer_load_dwordx4 v[128:131], v2, s[32:35], s51 offen offset:0 sc1
    buffer_load_dwordx4 v[132:135], v2, s[32:35], s51 offen offset:1024 sc1
    buffer_load_dwordx4 v[136:139], v2, s[32:35], s51 offen offset:2048 sc1
    buffer_load_dwordx4 v[140:143], v2, s[32:35], s51 offen offset:3072 sc1
    s_waitcnt vmcnt(6)
    s_lshl2_add_u32 s51, s72, s53
    buffer_load_dwordx4 v[144:147], v2, s[32:35], s51 offen offset:0 sc1
    buffer_load_dwordx4 v[148:151], v2, s[32:35], s51 offen offset:1024 sc1
    buffer_load_dwordx4 v[152:155], v2, s[32:35], s51 offen offset:2048 sc1
    buffer_load_dwordx4 v[156:159], v2, s[32:35], s51 offen offset:3072 sc1
    s_waitcnt vmcnt(6)
    s_lshl2_add_u32 s51, s73, s53
    buffer_load_dwordx4 v[160:163], v2, s[32:35], s51 offen offset:0 sc1
    buffer_load_dwordx4 v[164:167], v2, s[32:35], s51 offen offset:1024 sc1
    buffer_load_dwordx4 v[168:171], v2, s[32:35], s51 offen offset:2048 sc1
    buffer_load_dwordx4 v[172:175], v2, s[32:35], s51 offen offset:3072 sc1
    s_waitcnt vmcnt(6)
    s_lshl2_add_u32 s51, s74, s53
    buffer_load_dwordx4 v[176:179], v2, s[32:35], s51 offen offset:0 sc1
    buffer_load_dwordx4 v[180:183], v2, s[32:35], s51 offen offset:1024 sc1
    buffer_load_dwordx4 v[184:187], v2, s[32:35], s51 offen offset:2048 sc1
    buffer_load_dwordx4 v[188:191], v2, s[32:35], s51 offen offset:3072 sc1
    s_waitcnt vmcnt(6)
    s_lshl2_add_u32 s51, s75, s53
    buffer_load_dwordx4 v[192:195], v2, s[32:35], s51 offen offset:0 sc1
    buffer_load_dwordx4 v[196:199], v2, s[32:35], s51 offen offset:1024 sc1
    buffer_load_dwordx4 v[200:203], v2, s[32:35], s51 offen offset:2048 sc1
    buffer_load_dwordx4 v[204:207], v2, s[32:35], s51 offen offset:3072 sc1
    s_waitcnt vmcnt(6)
    s_lshl2_add_u32 s51, s76, s53
    buffer_load_dwordx4 v[208:211], v2, s[32:35], s51 offen offset:0 sc1
    buffer_load_dwordx4 v[212:215], v2, s[32:35], s51 offen offset:1024 sc1
    buffer_load_dwordx4 v[216:219], v2, s[32:35], s51 offen offset:2048 sc1
    buffer_load_dwordx4 v[220:223], v2, s[32:35], s51 offen offset:3072 sc1
    s_waitcnt vmcnt(6)
    s_lshl2_add_u32 s51, s77, s53
    buffer_load_dwordx4 v[224:227], v2, s[32:35], s51 offen offset:0 sc1
    buffer_load_dwordx4 v[228:231], v2, s[32:35], s51 offen offset:1024 sc1
    buffer_load_dwordx4 v[232:235], v2, s[32:35], s51 offen offset:2048 sc1
    buffer_load_dwordx4 v[236:239], v2, s[32:35], s51 offen offset:3072 sc1
    s_waitcnt vmcnt(6)
    s_lshl2_add_u32 s51, s78, s53
    buffer_load_dwordx4 v[240:243], v2, s[32:35], s51 offen offset:0 sc1
    buffer_load_dwordx4 v[244:247], v2, s[32:35], s51 offen offset:1024 sc1
    buffer_load_dwordx4 v[248:251], v2, s[32:35], s51 offen offset:2048 sc1
    buffer_load_dwordx4 v[252:255], v2, s[32:35], s51 offen offset:3072 sc1
    v_mov_b32 v16, s49
    s_mov_b32 s48, 0
L_cue_8:
    ds_read_b32 v1, v16 offset:15360
    s_add_u32 s48, s48, 1
    s_waitcnt lgkmcnt(0)
    v_cmp_ne_u32 vcc, 0, v1
    s_cbranch_vccnz L_cued_9
    s_sleep 1
    s_cmp_lt_u32 s48, 200000
    s_cbranch_scc1 L_cue_8
L_cued_9:
    v_add_u32 v0, s52, v2
    v_mov_b32 v2, v13
    v_mov_b32 v3, v14
    s_waitcnt vmcnt(9)
    s_add_u32 s51, s68, 0
    buffer_load_dwordx4 v[4:7], v0, s[32:35], s51 offen sc1
    s_waitcnt vmcnt(9)
    s_add_u32 s51, s69, 0
    buffer_load_dwordx4 v[8:11], v0, s[32:35], s51 offen sc1
    s_waitcnt vmcnt(9)
    s_add_u32 s51, s70, 0
    buffer_load_dwordx4 v[12:15], v0, s[32:35], s51 offen sc1
    s_waitcnt vmcnt(9)
    s_add_u32 s51, s71, 0
    buffer_load_dwordx4 v[16:19], v0, s[32:35], s51 offen sc1
    s_waitcnt vmcnt(9)
    s_add_u32 s51, s72, 0
    buffer_load_dwordx4 v[20:23], v0, s[32:35], s51 offen sc1
    s_waitcnt vmcnt(9)
    s_add_u32 s51, s73, 0
    buffer_load_dwordx4 v[24:27], v0, s[32:35], s51 offen sc1
    s_waitcnt vmcnt(9)
    s_add_u32 s51, s74, 0
    buffer_load_dwordx4 v[28:31], v0, s[32:35], s51 offen sc1
    s_waitcnt vmcnt(9)
    s_add_u32 s51, s75, 0
    buffer_load_dwordx4 v[32:35], v0, s[32:35], s51 offen sc1
    s_waitcnt vmcnt(9)
    s_add_u32 s51, s76, 0
    buffer_load_dwordx4 v[36:39], v0, s[32:35], s51 offen sc1
    s_waitcnt vmcnt(9)
    s_add_u32 s51, s77, 0
    buffer_load_dwordx4 v[40:43], v0, s[32:35], s51 offen sc1
    s_waitcnt vmcnt(9)
    s_add_u32 s51, s78, 0
    buffer_load_dwordx4 v[44:47], v0, s[32:35], s51 offen sc1
    v_mfma_f32_16x16x32_bf16 v[48:51], v[80:83], v[4:7], 0
    v_mfma_f32_16x16x32_bf16 v[52:55], v[84:87], v[4:7], 0
    v_mfma_f32_16x16x32_bf16 v[56:59], v[88:91], v[4:7], 0
    v_mfma_f32_16x16x32_bf16 v[60:63], v[92:95], v[4:7], 0
    s_waitcnt vmcnt(9)
    s_add_u32 s51, s68, 45056
    v_mfma_f32_16x16x32_bf16 v[48:51], v[96:99], v[8:11], v[48:51]
    buffer_load_dwordx4 v[4:7], v0, s[32:35], s51 offen sc1
    v_mfma_f32_16x16x32_bf16 v[52:55], v[100:103], v[8:11], v[52:55]
    v_mfma_f32_16x16x32_bf16 v[56:59], v[104:107], v[8:11], v[56:59]
    v_mfma_f32_16x16x32_bf16 v[60:63], v[108:111], v[8:11], v[60:63]
    s_waitcnt vmcnt(9)
    s_add_u32 s51, s69, 45056
    v_mfma_f32_16x16x32_bf16 v[48:51], v[112:115], v[12:15], v[48:51]
    buffer_load_dwordx4 v[8:11], v0, s[32:35], s51 offen sc1
    v_mfma_f32_16x16x32_bf16 v[52:55], v[116:119], v[12:15], v[52:55]
    v_mfma_f32_16x16x32_bf16 v[56:59], v[120:123], v[12:15], v[56:59]
    v_mfma_f32_16x16x32_bf16 v[60:63], v[124:127], v[12:15], v[60:63]
    s_waitcnt vmcnt(9)
    s_add_u32 s51, s70, 45056
    v_mfma_f32_16x16x32_bf16 v[48:51], v[128:131], v[16:19], v[48:51]
    buffer_load_dwordx4 v[12:15], v0, s[32:35], s51 offen sc1
    v_mfma_f32_16x16x32_bf16 v[52:55], v[132:135], v[16:19], v[52:55]
    v_mfma_f32_16x16x32_bf16 v[56:59], v[136:139], v[16:19], v[56:59]
    v_mfma_f32_16x16x32_bf16 v[60:63], v[140:143], v[16:19], v[60:63]
    s_waitcnt vmcnt(9)
    s_add_u32 s51, s71, 45056
    v_mfma_f32_16x16x32_bf16 v[48:51], v[144:147], v[20:23], v[48:51]
    buffer_load_dwordx4 v[16:19], v0, s[32:35], s51 offen sc1
    v_mfma_f32_16x16x32_bf16 v[52:55], v[148:151], v[20:23], v[52:55]
    v_mfma_f32_16x16x32_bf16 v[56:59], v[152:155], v[20:23], v[56:59]
    v_mfma_f32_16x16x32_bf16 v[60:63], v[156:159], v[20:23], v[60:63]
    s_waitcnt vmcnt(9)
    s_add_u32 s51, s72, 45056
    v_mfma_f32_16x16x32_bf16 v[48:51], v[160:163], v[24:27], v[48:51]
    buffer_load_dwordx4 v[20:23], v0, s[32:35], s51 offen sc1
    v_mfma_f32_16x16x32_bf16 v[52:55], v[164:167], v[24:27], v[52:55]
    v_mfma_f32_16x16x32_bf16 v[56:59], v[168:171], v[24:27], v[56:59]
    v_mfma_f32_16x16x32_bf16 v[60:63], v[172:175], v[24:27], v[60:63]
    s_waitcnt vmcnt(9)
    s_add_u32 s51, s73, 45056
    v_mfma_f32_16x16x32_bf16 v[48:51], v[176:179], v[28:31], v[48:51]
    buffer_load_dwordx4 v[24:27], v0, s[32:35], s51 offen sc1
    v_mfma_f32_16x16x32_bf16 v[52:55], v[180:183], v[28:31], v[52:55]
    v_mfma_f32_16x16x32_bf16 v[56:59], v[184:187], v[28:31], v[56:59]
    v_mfma_f32_16x16x32_bf16 v[60:63], v[188:191], v[28:31], v[60:63]
    s_waitcnt vmcnt(9)
    s_add_u32 s51, s74, 45056
    v_mfma_f32_16x16x32_bf16 v[48:51], v[192:195], v[32:35], v[48:51]
    buffer_load_dwordx4 v[28:31], v0, s[32:35], s51 offen sc1
    v_mfma_f32_16x16x32_bf16 v[52:55], v[196:199], v[32:35], v[52:55]
    v_mfma_f32_16x16x32_bf16 v[56:59], v[200:203], v[32:35], v[56:59]
    v_mfma_f32_16x16x32_bf16 v[60:63], v[204:207], v[32:35], v[60:63]
    s_waitcnt vmcnt(9)
    s_add_u32 s51, s75, 45056
    v_mfma_f32_16x16x32_bf16 v[48:51], v[208:211], v[36:39], v[48:51]
    buffer_load_dwordx4 v[32:35], v0, s[32:35], s51 offen sc1
    v_mfma_f32_16x16x32_bf16 v[52:55], v[212:215], v[36:39], v[52:55]
    v_mfma_f32_16x16x32_bf16 v[56:59], v[216:219], v[36:39], v[56:59]
    v_mfma_f32_16x16x32_bf16 v[60:63], v[220:223], v[36:39], v[60:63]
    s_waitcnt vmcnt(9)
    s_add_u32 s51, s76, 45056
    v_mfma_f32_16x16x32_bf16 v[48:51], v[224:227], v[40:43], v[48:51]
    buffer_load_dwordx4 v[36:39], v0, s[32:35], s51 offen sc1
    v_mfma_f32_16x16x32_bf16 v[52:55], v[228:231], v[40:43], v[52:55]
    v_mfma_f32_16x16x32_bf16 v[56:59], v[232:235], v[40:43], v[56:59]
    v_mfma_f32_16x16x32_bf16 v[60:63], v[236:239], v[40:43], v[60:63]
    s_waitcnt vmcnt(9)
    s_add_u32 s51, s77, 45056
    v_mfma_f32_16x16x32_bf16 v[48:51], v[240:243], v[44:47], v[48:51]
    buffer_load_dwordx4 v[40:43], v0, s[32:35], s51 offen sc1
    v_mfma_f32_16x16x32_bf16 v[52:55], v[244:247], v[44:47], v[52:55]
    v_mfma_f32_16x16x32_bf16 v[56:59], v[248:251], v[44:47], v[56:59]
    v_mfma_f32_16x16x32_bf16 v[60:63], v[252:255], v[44:47], v[60:63]
    s_waitcnt vmcnt(9)
    s_add_u32 s51, s78, 45056
    v_mfma_f32_16x16x32_bf16 v[64:67], v[80:83], v[4:7], 0
    buffer_load_dwordx4 v[44:47], v0, s[32:35], s51 offen sc1
    v_mfma_f32_16x16x32_bf16 v[68:71], v[84:87], v[4:7], 0
    v_cmp_u_f32 vcc, v48, v48
    v_mfma_f32_16x16x32_bf16 v[72:75], v[88:91], v[4:7], 0
    v_mfma_f32_16x16x32_bf16 v[76:79], v[92:95], v[4:7], 0
    s_cbranch_vccnz L_redo_10
L_redone_11:
    s_waitcnt vmcnt(9)
    s_add_u32 s51, s68, 90112
    v_mfma_f32_16x16x32_bf16 v[64:67], v[96:99], v[8:11], v[64:67]
    buffer_load_dwordx4 v[4:7], v0, s[32:35], s51 offen sc1
    v_mfma_f32_16x16x32_bf16 v[68:71], v[100:103], v[8:11], v[68:71]
    ds_write_b128 v2, v[48:51] offset:0
    v_mfma_f32_16x16x32_bf16 v[72:75], v[104:107], v[8:11], v[72:75]
    v_mfma_f32_16x16x32_bf16 v[76:79], v[108:111], v[8:11], v[76:79]
    s_waitcnt vmcnt(9)
    s_add_u32 s51, s69, 90112
    v_mfma_f32_16x16x32_bf16 v[64:67], v[112:115], v[12:15], v[64:67]
    buffer_load_dwordx4 v[8:11], v0, s[32:35], s51 offen sc1
    v_mfma_f32_16x16x32_bf16 v[68:71], v[116:119], v[12:15], v[68:71]
    ds_write_b128 v3, v[52:55] offset:0
    v_mfma_f32_16x16x32_bf16 v[72:75], v[120:123], v[12:15], v[72:75]
    v_mfma_f32_16x16x32_bf16 v[76:79], v[124:127], v[12:15], v[76:79]
    s_waitcnt vmcnt(9)
    s_add_u32 s51, s70, 90112
    v_mfma_f32_16x16x32_bf16 v[64:67], v[128:131], v[16:19], v[64:67]
    buffer_load_dwordx4 v[12:15], v0, s[32:35], s51 offen sc1
    v_mfma_f32_16x16x32_bf16 v[68:71], v[132:135], v[16:19], v[68:71]
    ds_write_b128 v2, v[56:59] offset:128
    v_mfma_f32_16x16x32_bf16 v[72:75], v[136:139], v[16:19], v[72:75]
    v_mfma_f32_16x16x32_bf16 v[76:79], v[140:143], v[16:19], v[76:79]
    s_waitcnt vmcnt(9)
    s_add_u32 s51, s71, 90112
    v_mfma_f32_16x16x32_bf16 v[64:67], v[144:147], v[20:23], v[64:67]
    buffer_load_dwordx4 v[16:19], v0, s[32:35], s51 offen sc1
    v_mfma_f32_16x16x32_bf16 v[68:71], v[148:151], v[20:23], v[68:71]
    ds_write_b128 v3, v[60:63] offset:128
    v_mfma_f32_16x16x32_bf16 v[72:75], v[152:155], v[20:23], v[72:75]
    v_mfma_f32_16x16x32_bf16 v[76:79], v[156:159], v[20:23], v[76:79]
    s_waitcnt vmcnt(9)
    s_add_u32 s51, s72, 90112
    v_mfma_f32_16x16x32_bf16 v[64:67], v[160:163], v[24:27], v[64:67]
    buffer_load_dwordx4 v[20:23], v0, s[32:35], s51 offen sc1
    v_mfma_f32_16x16x32_bf16 v[68:71], v[164:167], v[24:27], v[68:71]
    s_waitcnt lgkmcnt(0)
    s_barrier
    v_mfma_f32_16x16x32_bf16 v[72:75], v[168:171], v[24:27], v[72:75]
    v_mfma_f32_16x16x32_bf16 v[76:79], v[172:175], v[24:27], v[76:79]
    s_waitcnt vmcnt(9)
    s_add_u32 s51, s73, 90112
    v_mfma_f32_16x16x32_bf16 v[64:67], v[176:179], v[28:31], v[64:67]
    buffer_load_dwordx4 v[24:27], v0, s[32:35], s51 offen sc1
    v_mfma_f32_16x16x32_bf16 v[68:71], v[180:183], v[28:31], v[68:71]
    v_mfma_f32_16x16x32_bf16 v[72:75], v[184:187], v[28:31], v[72:75]
    v_mfma_f32_16x16x32_bf16 v[76:79], v[188:191], v[28:31], v[76:79]
    s_waitcnt vmcnt(9)
    s_add_u32 s51, s74, 90112
    v_mfma_f32_16x16x32_bf16 v[64:67], v[192:195], v[32:35], v[64:67]
    buffer_load_dwordx4 v[28:31], v0, s[32:35], s51 offen sc1
    v_mfma_f32_16x16x32_bf16 v[68:71], v[196:199], v[32:35], v[68:71]
    v_mfma_f32_16x16x32_bf16 v[72:75], v[200:203], v[32:35], v[72:75]
    v_mfma_f32_16x16x32_bf16 v[76:79], v[204:207], v[32:35], v[76:79]
    s_waitcnt vmcnt(9)
    s_add_u32 s51, s75, 90112
    v_mfma_f32_16x16x32_bf16 v[64:67], v[208:211], v[36:39], v[64:67]
    buffer_load_dwordx4 v[32:35], v0, s[32:35], s51 offen sc1
    v_mfma_f32_16x16x32_bf16 v[68:71], v[212:215], v[36:39], v[68:71]
    v_mfma_f32_16x16x32_bf16 v[72:75], v[216:219], v[36:39], v[72:75]
    v_mfma_f32_16x16x32_bf16 v[76:79], v[220:223], v[36:39], v[76:79]
    s_waitcnt vmcnt(9)
    s_add_u32 s51, s76, 90112
    v_mfma_f32_16x16x32_bf16 v[64:67], v[224:227], v[40:43], v[64:67]
    buffer_load_dwordx4 v[36:39], v0, s[32:35], s51 offen sc1
    v_mfma_f32_16x16x32_bf16 v[68:71], v[228:231], v[40:43], v[68:71]
    v_mfma_f32_16x16x32_bf16 v[72:75], v[232:235], v[40:43], v[72:75]
    v_mfma_f32_16x16x32_bf16 v[76:79], v[236:239], v[40:43], v[76:79]
    s_waitcnt vmcnt(9)
    s_add_u32 s51, s77, 90112
    v_mfma_f32_16x16x32_bf16 v[64:67], v[240:243], v[44:47], v[64:67]
    buffer_load_dwordx4 v[40:43], v0, s[32:35], s51 offen sc1
    v_mfma_f32_16x16x32_bf16 v[68:71], v[244:247], v[44:47], v[68:71]
    v_mfma_f32_16x16x32_bf16 v[72:75], v[248:251], v[44:47], v[72:75]
    v_mfma_f32_16x16x32_bf16 v[76:79], v[252:255], v[44:47], v[76:79]
    s_waitcnt vmcnt(9)
    s_add_u32 s51, s78, 90112
    v_mfma_f32_16x16x32_bf16 v[48:51], v[80:83], v[4:7], 0
    buffer_load_dwordx4 v[44:47], v0, s[32:35], s51 offen sc1
    v_mfma_f32_16x16x32_bf16 v[52:55], v[84:87], v[4:7], 0
    v_cmp_u_f32 vcc, v64, v64
    v_mfma_f32_16x16x32_bf16 v[56:59], v[88:91], v[4:7], 0
    v_mfma_f32_16x16x32_bf16 v[60:63], v[92:95], v[4:7], 0
    s_cbranch_vccnz L_redo_12
L_redone_13:
    s_waitcnt vmcnt(9)
    s_add_u32 s51, s68, 135168
    v_mfma_f32_16x16x32_bf16 v[48:51], v[96:99], v[8:11], v[48:51]
    buffer_load_dwordx4 v[4:7], v0, s[32:35], s51 offen sc1
    v_mfma_f32_16x16x32_bf16 v[52:55], v[100:103], v[8:11], v[52:55]
    ds_write_b128 v2, v[64:67] offset:16384
    v_mfma_f32_16x16x32_bf16 v[56:59], v[104:107], v[8:11], v[56:59]
    v_mfma_f32_16x16x32_bf16 v[60:63], v[108:111], v[8:11], v[60:63]
    s_waitcnt vmcnt(9)
    s_add_u32 s51, s69, 135168
    v_mfma_f32_16x16x32_bf16 v[48:51], v[112:115], v[12:15], v[48:51]
    buffer_load_dwordx4 v[8:11], v0, s[32:35], s51 offen sc1
    v_mfma_f32_16x16x32_bf16 v[52:55], v[116:119], v[12:15], v[52:55]
    ds_write_b128 v3, v[68:71] offset:16384
    v_mfma_f32_16x16x32_bf16 v[56:59], v[120:123], v[12:15], v[56:59]
    v_mfma_f32_16x16x32_bf16 v[60:63], v[124:127], v[12:15], v[60:63]
    s_waitcnt vmcnt(9)
    s_add_u32 s51, s70, 135168
    v_mfma_f32_16x16x32_bf16 v[48:51], v[128:131], v[16:19], v[48:51]
    buffer_load_dwordx4 v[12:15], v0, s[32:35], s51 offen sc1
    v_mfma_f32_16x16x32_bf16 v[52:55], v[132:135], v[16:19], v[52:55]
    ds_write_b128 v2, v[72:75] offset:16512
    v_mfma_f32_16x16x32_bf16 v[56:59], v[136:139], v[16:19], v[56:59]
    v_mfma_f32_16x16x32_bf16 v[60:63], v[140:143], v[16:19], v[60:63]
    s_waitcnt vmcnt(9)
    s_add_u32 s51, s71, 135168
    v_mfma_f32_16x16x32_bf16 v[48:51], v[144:147], v[20:23], v[48:51]
    buffer_load_dwordx4 v[16:19], v0, s[32:35], s51 offen sc1
    v_mfma_f32_16x16x32_bf16 v[52:55], v[148:151], v[20:23], v[52:55]
    ds_write_b128 v3, v[76:79] offset:16512
    v_mfma_f32_16x16x32_bf16 v[56:59], v[152:155], v[20:23], v[56:59]
    v_mfma_f32_16x16x32_bf16 v[60:63], v[156:159], v[20:23], v[60:63]
    s_waitcnt vmcnt(9)
    s_add_u32 s51, s72, 135168
    v_mfma_f32_16x16x32_bf16 v[48:51], v[160:163], v[24:27], v[48:51]
    buffer_load_dwordx4 v[20:23], v0, s[32:35], s51 offen sc1
    v_mfma_f32_16x16x32_bf16 v[52:55], v[164:167], v[24:27], v[52:55]
    s_waitcnt lgkmcnt(0)
    s_barrier
    v_mfma_f32_16x16x32_bf16 v[56:59], v[168:171], v[24:27], v[56:59]
    v_mfma_f32_16x16x32_bf16 v[60:63], v[172:175], v[24:27], v[60:63]
    s_waitcnt vmcnt(9)
    s_add_u32 s51, s73, 135168
    v_mfma_f32_16x16x32_bf16 v[48:51], v[176:179], v[28:31], v[48:51]
    buffer_load_dwordx4 v[24:27], v0, s[32:35], s51 offen sc1
    v_mfma_f32_16x16x32_bf16 v[52:55], v[180:183], v[28:31], v[52:55]
    v_mfma_f32_16x16x32_bf16 v[56:59], v[184:187], v[28:31], v[56:59]
    v_mfma_f32_16x16x32_bf16 v[60:63], v[188:191], v[28:31], v[60:63]
    s_waitcnt vmcnt(9)
    s_add_u32 s51, s74, 135168
    v_mfma_f32_16x16x32_bf16 v[48:51], v[192:195], v[32:35], v[48:51]
    buffer_load_dwordx4 v[28:31], v0, s[32:35], s51 offen sc1
    v_mfma_f32_16x16x32_bf16 v[52:55], v[196:199], v[32:35], v[52:55]
    v_mfma_f32_16x16x32_bf16 v[56:59], v[200:203], v[32:35], v[56:59]
    v_mfma_f32_16x16x32_bf16 v[60:63], v[204:207], v[32:35], v[60:63]
    s_waitcnt vmcnt(9)
    s_add_u32 s51, s75, 135168
    v_mfma_f32_16x16x32_bf16 v[48:51], v[208:211], v[36:39], v[48:51]
    buffer_load_dwordx4 v[32:35], v0, s[32:35], s51 offen sc1
    v_mfma_f32_16x16x32_bf16 v[52:55], v[212:215], v[36:39], v[52:55]
    v_mfma_f32_16x16x32_bf16 v[56:59], v[216:219], v[36:39], v[56:59]
    v_mfma_f32_16x16x32_bf16 v[60:63], v[220:223], v[36:39], v[60:63]
    s_waitcnt vmcnt(9)
    s_add_u32 s51, s76, 135168
    v_mfma_f32_16x16x32_bf16 v[48:51], v[224:227], v[40:43], v[48:51]
    buffer_load_dwordx4 v[36:39], v0, s[32:35], s51 offen sc1
    v_mfma_f32_16x16x32_bf16 v[52:55], v[228:231], v[40:43], v[52:55]
    v_mfma_f32_16x16x32_bf16 v[56:59], v[232:235], v[40:43], v[56:59]
    v_mfma_f32_16x16x32_bf16 v[60:63], v[236:239], v[40:43], v[60:63]
    s_waitcnt vmcnt(9)
    s_add_u32 s51, s77, 135168
    v_mfma_f32_16x16x32_bf16 v[48:51], v[240:243], v[44:47], v[48:51]
    buffer_load_dwordx4 v[40:43], v0, s[32:35], s51 offen sc1
    v_mfma_f32_16x16x32_bf16 v[52:55], v[244:247], v[44:47], v[52:55]
    v_mfma_f32_16x16x32_bf16 v[56:59], v[248:251], v[44:47], v[56:59]
    v_mfma_f32_16x16x32_bf16 v[60:63], v[252:255], v[44:47], v[60:63]
    s_waitcnt vmcnt(9)
    s_add_u32 s51, s78, 135168
    v_mfma_f32_16x16x32_bf16 v[64:67], v[80:83], v[4:7], 0
    buffer_load_dwordx4 v[44:47], v0, s[32:35], s51 offen sc1
    v_mfma_f32_16x16x32_bf16 v[68:71], v[84:87], v[4:7], 0
    v_cmp_u_f32 vcc, v48, v48
    v_mfma_f32_16x16x32_bf16 v[72:75], v[88:91], v[4:7], 0
    v_mfma_f32_16x16x32_bf16 v[76:79], v[92:95], v[4:7], 0
    s_cbranch_vccnz L_redo_14
L_redone_15:
    s_waitcnt vmcnt(9)
    v_mfma_f32_16x16x32_bf16 v[64:67], v[96:99], v[8:11], v[64:67]
    v_mfma_f32_16x16x32_bf16 v[68:71], v[100:103], v[8:11], v[68:71]
    ds_write_b128 v2, v[48:51] offset:0
    v_mfma_f32_16x16x32_bf16 v[72:75], v[104:107], v[8:11], v[72:75]
    v_mfma_f32_16x16x32_bf16 v[76:79], v[108:111], v[8:11], v[76:79]
    s_waitcnt vmcnt(8)
    v_mfma_f32_16x16x32_bf16 v[64:67], v[112:115], v[12:15], v[64:67]
    v_mfma_f32_16x16x32_bf16 v[68:71], v[116:119], v[12:15], v[68:71]
    ds_write_b128 v3, v[52:55] offset:0
    v_mfma_f32_16x16x32_bf16 v[72:75], v[120:123], v[12:15], v[72:75]
    v_mfma_f32_16x16x32_bf16 v[76:79], v[124:127], v[12:15], v[76:79]
    s_waitcnt vmcnt(7)
    v_mfma_f32_16x16x32_bf16 v[64:67], v[128:131], v[16:19], v[64:67]
    v_mfma_f32_16x16x32_bf16 v[68:71], v[132:135], v[16:19], v[68:71]
    ds_write_b128 v2, v[56:59] offset:128
    v_mfma_f32_16x16x32_bf16 v[72:75], v[136:139], v[16:19], v[72:75]
    v_mfma_f32_16x16x32_bf16 v[76:79], v[140:143], v[16:19], v[76:79]
    s_waitcnt vmcnt(6)
    v_mfma_f32_16x16x32_bf16 v[64:67], v[144:147], v[20:23], v[64:67]
    v_mfma_f32_16x16x32_bf16 v[68:71], v[148:151], v[20:23], v[68:71]
    ds_write_b128 v3, v[60:63] offset:128
    v_mfma_f32_16x16x32_bf16 v[72:75], v[152:155], v[20:23], v[72:75]
    v_mfma_f32_16x16x32_bf16 v[76:79], v[156:159], v[20:23], v[76:79]
    s_waitcnt vmcnt(5)
    v_mfma_f32_16x16x32_bf16 v[64:67], v[160:163], v[24:27], v[64:67]
    v_mfma_f32_16x16x32_bf16 v[68:71], v[164:167], v[24:27], v[68:71]
    s_waitcnt lgkmcnt(0)
    s_barrier
    v_mfma_f32_16x16x32_bf16 v[72:75], v[168:171], v[24:27], v[72:75]
    v_mfma_f32_16x16x32_bf16 v[76:79], v[172:175], v[24:27], v[76:79]
    s_waitcnt vmcnt(4)
    v_mfma_f32_16x16x32_bf16 v[64:67], v[176:179], v[28:31], v[64:67]
    v_mfma_f32_16x16x32_bf16 v[68:71], v[180:183], v[28:31], v[68:71]
    v_mfma_f32_16x16x32_bf16 v[72:75], v[184:187], v[28:31], v[72:75]
    v_mfma_f32_16x16x32_bf16 v[76:79], v[188:191], v[28:31], v[76:79]
    s_waitcnt vmcnt(3)
    v_mfma_f32_16x16x32_bf16 v[64:67], v[192:195], v[32:35], v[64:67]
    v_mfma_f32_16x16x32_bf16 v[68:71], v[196:199], v[32:35], v[68:71]
    v_mfma_f32_16x16x32_bf16 v[72:75], v[200:203], v[32:35], v[72:75]
    v_mfma_f32_16x16x32_bf16 v[76:79], v[204:207], v[32:35], v[76:79]
    s_waitcnt vmcnt(2)
    v_mfma_f32_16x16x32_bf16 v[64:67], v[208:211], v[36:39], v[64:67]
    s_waitcnt vmcnt(1)
    v_mfma_f32_16x16x32_bf16 v[64:67], v[224:227], v[40:43], v[64:67]
    s_waitcnt vmcnt(0)
    v_mfma_f32_16x16x32_bf16 v[64:67], v[240:243], v[44:47], v[64:67]
    v_mfma_f32_16x16x32_bf16 v[68:71], v[212:215], v[36:39], v[68:71]
    v_mfma_f32_16x16x32_bf16 v[68:71], v[228:231], v[40:43], v[68:71]
    v_mfma_f32_16x16x32_bf16 v[68:71], v[244:247], v[44:47], v[68:71]
    v_mfma_f32_16x16x32_bf16 v[72:75], v[216:219], v[36:39], v[72:75]
    v_mfma_f32_16x16x32_bf16 v[72:75], v[232:235], v[40:43], v[72:75]
    v_mfma_f32_16x16x32_bf16 v[72:75], v[248:251], v[44:47], v[72:75]
    s_nop 1
    ds_write_b128 v2, v[64:67] offset:16384
    v_mfma_f32_16x16x32_bf16 v[76:79], v[220:223], v[36:39], v[76:79]
    v_mfma_f32_16x16x32_bf16 v[76:79], v[236:239], v[40:43], v[76:79]
    v_cmp_u_f32 vcc, v64, v64
    v_mfma_f32_16x16x32_bf16 v[76:79], v[252:255], v[44:47], v[76:79]
    ds_write_b128 v3, v[68:71] offset:16384
    ds_write_b128 v2, v[72:75] offset:16512
    s_nop 5
    ds_write_b128 v3, v[76:79] offset:16512
    s_cbranch_vccz L_final_17
    s_cbranch_vccnz L_redo_18
L_redone_19:
    ds_write_b128 v2, v[64:67] offset:16384
    ds_write_b128 v3, v[68:71] offset:16384
    ds_write_b128 v2, v[72:75] offset:16512
    ds_write_b128 v3, v[76:79] offset:16512
L_final_17:
    s_waitcnt lgkmcnt(0)
    s_barrier
L_end:
    s_endpgm
L_contB:
    v_and_b32 v4, 63, v0
    s_mov_b32 s34, 20971520
    s_mov_b32 s35, 0x20000
    s_and_b32 s36, s3, 3
    s_lshl_b32 s50, s38, 5
    s_or_b32 s50, s50, s39
    s_and_b32 s40, s39, 7
    s_lshr_b32 s41, s39, 3
    s_mul_i32 s41, s41, 0
    s_mul_i32 s42, s38, 4
    s_xor_b32 s41, s41, s42
    s_and_b32 s41, s41, 12
    v_mov_b32 v3, 0
    v_lshlrev_b32 v2, 4, v4
    v_mov_b32 v8, -1
    v_mov_b32 v9, -1
    v_mov_b32 v10, -1
    v_mov_b32 v11, -1
    s_lshl_b32 s42, s50, 13
    s_lshl_b32 s43, s36, 11
    s_add_u32 s55, s42, s43
    s_lshr_b32 s52, s55, 2
    s_mul_i32 s52, s52, 11
    s_lshr_b32 s42, s76, 4
    s_lshl_b32 s42, s42, 16
    s_and_b32 s43, s76, 15
    s_lshl_b32 s43, s43, 10
    s_add_u32 s42, s42, s43
    s_add_u32 s42, s42, 16777216
    s_sub_u32 s43, s76, 352
    s_and_b32 s44, s43, 7
    s_mul_i32 s44, s44, 43
    s_lshr_b32 s43, s43, 3
    s_add_u32 s43, s43, s44
    s_lshl_b32 s43, s43, 12
    s_add_u32 s43, s43, 18874368
    s_cmp_lt_u32 s76, 696
    s_cselect_b32 s43, s43, 2.0
    s_movk_i32 s44, 1024
    s_cmp_lt_u32 s76, 352
    s_cselect_b32 s72, s42, s43
    s_cselect_b32 s42, 16384, s44
    s_cselect_b32 s43, 512, s44
    s_cselect_b32 s44, 0, 1
    s_add_u32 s73, s72, s42
    s_add_u32 s74, s73, s42
    s_add_u32 s75, s74, s42
    v_and_b32 v1, s44, v6
    v_lshlrev_b32 v12, 1, v6
    v_sub_u32 v1, v12, v1
    v_lshl_add_u32 v1, v1, 9, s49
    v_and_b32 v12, 12, v4
    v_lshl_add_u32 v1, v12, 5, v1
    v_and_b32 v12, 3, v4
    v_lshl_add_u32 v12, v12, 3, v1
    v_add_u32 v13, s43, v12
    v_mul_u32_u24 v1, 1040, v5
    v_lshl_add_u32 v61, v6, 8, v1
    s_lshr_b32 s54, s50, 3
    s_mul_i32 s54, s54, 180224
    s_add_u32 s54, s54, 8388608
    s_lshl_b32 s42, s40, 2
    s_add_u32 s42, s42, s36
    s_lshl_b32 s4, s42, 10
    s_lshl_b32 s42, s42, 15
    s_mul_i32 s43, s40, 3
    s_add_u32 s43, s43, s36
    s_cmp_eq_u32 s40, 7
    s_subb_u32 s43, s43, 0
    s_cmp_ge_u32 s40, 6
    s_addc_u32 s44, s36, 0
    s_lshl_b32 s5, s43, 9
    s_add_u32 s5, s5, 32768
    s_lshl_b32 s43, s43, 14
    s_add_u32 s43, s43, 1048576
    s_cmp_lt_u32 s44, 3
    s_cselect_b32 s5, s5, 2.0
    s_cselect_b32 s43, s43, 2.0
    v_add_u32 v48, s42, v2
    v_add_u32 v49, 16384, v48
    v_add_u32 v50, s43, v2
    s_xor_b32 s42, s41, 0
    s_lshl_b32 s42, s42, 10
    s_add_u32 s60, s42, 16777216
    s_xor_b32 s42, s41, 4
    s_lshl_b32 s42, s42, 10
    s_add_u32 s61, s42, 16777216
    s_xor_b32 s42, s41, 8
    s_lshl_b32 s42, s42, 10
    s_add_u32 s62, s42, 16777216
    s_xor_b32 s42, s41, 12
    s_lshl_b32 s42, s42, 10
    s_add_u32 s63, s42, 16777216
    v_cmp_gt_u32 vcc, 32, v4
    v_add_u32 v62, s4, v2
    v_add_u32 v63, s5, v2
    v_cndmask_b32 v63, 2.0, v63, vcc
    s_add_u32 s56, s54, 0
    s_add_u32 s57, s54, 45056
    s_add_u32 s58, s54, 90112
    s_add_u32 s59, s54, 135168
    s_mul_i32 s42, s36, 16128
    s_add_u32 s42, s42, 114688
    v_mov_b32 v60, s42
    s_barrier
    s_barrier
    s_waitcnt vmcnt(0)
    ds_read_b64_tr_b16 v[180:181], v12 offset:0
    ds_read_b64_tr_b16 v[182:183], v13 offset:0
    ds_read_b64_tr_b16 v[184:185], v12 offset:32
    ds_read_b64_tr_b16 v[186:187], v13 offset:32
    ds_read_b64_tr_b16 v[188:189], v12 offset:64
    ds_read_b64_tr_b16 v[190:191], v13 offset:64
    ds_read_b64_tr_b16 v[192:193], v12 offset:96
    ds_read_b64_tr_b16 v[194:195], v13 offset:96
    s_waitcnt lgkmcnt(6)
    buffer_store_dwordx4 v[180:183], v2, s[32:35], s72 offen sc1
    s_waitcnt lgkmcnt(4)
    buffer_store_dwordx4 v[184:187], v2, s[32:35], s73 offen sc1
    s_waitcnt lgkmcnt(2)
    buffer_store_dwordx4 v[188:191], v2, s[32:35], s74 offen sc1
    s_waitcnt lgkmcnt(0)
    buffer_store_dwordx4 v[192:195], v2, s[32:35], s75 offen sc1
    s_barrier
    s_add_u32 s53, s52, 8388608
    buffer_store_dwordx4 v[8:11], v2, s[32:35], s53 offen sc1
    s_add_u32 s53, s52, 8389632
    buffer_store_dwordx4 v[8:11], v2, s[32:35], s53 offen sc1
    s_add_u32 s53, s52, 8390656
    buffer_store_dwordx4 v[8:11], v2, s[32:35], s53 offen sc1
    s_waitcnt vmcnt(3)
    s_barrier
    s_barrier
    s_add_u32 s53, s52, 8391680
    buffer_store_dwordx4 v[8:11], v2, s[32:35], s53 offen sc1
    s_add_u32 s53, s52, 8392704
    buffer_store_dwordx4 v[8:11], v2, s[32:35], s53 offen sc1
    s_add_u32 s53, s52, 8393728
    s_mov_b32 exec_hi, 0
    buffer_store_dwordx4 v[8:11], v2, s[32:35], s53 offen sc1
    s_mov_b32 exec_hi, -1
    s_barrier
    buffer_load_dwordx4 v[64:67], v48, s[32:35], s60 offen offset:0 sc1
    buffer_load_dwordx4 v[68:71], v49, s[32:35], s60 offen offset:0 sc1
    buffer_load_dwordx4 v[72:75], v50, s[32:35], s60 offen offset:0 sc1
    buffer_load_dwordx4 v[76:79], v48, s[32:35], s60 offen offset:1024 sc1
    buffer_load_dwordx4 v[80:83], v49, s[32:35], s60 offen offset:1024 sc1
    buffer_load_dwordx4 v[84:87], v50, s[32:35], s60 offen offset:1024 sc1
    buffer_load_dwordx4 v[88:91], v48, s[32:35], s60 offen offset:2048 sc1
    buffer_load_dwordx4 v[92:95], v49, s[32:35], s60 offen offset:2048 sc1
    buffer_load_dwordx4 v[96:99], v50, s[32:35], s60 offen offset:2048 sc1
    s_waitcnt vmcnt(9)
    s_barrier
    s_waitcnt vmcnt(10)
    buffer_load_dwordx4 v[100:103], v48, s[32:35], s60 offen offset:3072 sc1
    buffer_load_dwordx4 v[104:107], v49, s[32:35], s60 offen offset:3072 sc1
    buffer_load_dwordx4 v[108:111], v50, s[32:35], s60 offen offset:3072 sc1
    s_waitcnt vmcnt(10)
    buffer_load_dwordx4 v[112:115], v48, s[32:35], s61 offen offset:0 sc1
    buffer_load_dwordx4 v[116:119], v49, s[32:35], s61 offen offset:0 sc1
    buffer_load_dwordx4 v[120:123], v50, s[32:35], s61 offen offset:0 sc1
    s_waitcnt vmcnt(10)
    buffer_load_dwordx4 v[124:127], v48, s[32:35], s61 offen offset:1024 sc1
    buffer_load_dwordx4 v[128:131], v49, s[32:35], s61 offen offset:1024 sc1
    buffer_load_dwordx4 v[132:135], v50, s[32:35], s61 offen offset:1024 sc1
    s_waitcnt vmcnt(10)
    buffer_load_dwordx4 v[136:139], v48, s[32:35], s61 offen offset:2048 sc1
    buffer_load_dwordx4 v[140:143], v49, s[32:35], s61 offen offset:2048 sc1
    buffer_load_dwordx4 v[144:147], v50, s[32:35], s61 offen offset:2048 sc1
    s_waitcnt vmcnt(10)
    buffer_load_dwordx4 v[148:151], v48, s[32:35], s61 offen offset:3072 sc1
    buffer_load_dwordx4 v[152:155], v49, s[32:35], s61 offen offset:3072 sc1
    buffer_load_dwordx4 v[156:159], v50, s[32:35], s61 offen offset:3072 sc1
    s_waitcnt vmcnt(10)
    buffer_load_dwordx4 v[160:163], v48, s[32:35], s62 offen offset:0 sc1
    buffer_load_dwordx4 v[164:167], v49, s[32:35], s62 offen offset:0 sc1
    buffer_load_dwordx4 v[168:171], v50, s[32:35], s62 offen offset:0 sc1
    s_waitcnt vmcnt(10)
    buffer_load_dwordx4 v[172:175], v48, s[32:35], s62 offen offset:1024 sc1
    buffer_load_dwordx4 v[176:179], v49, s[32:35], s62 offen offset:1024 sc1
    buffer_load_dwordx4 v[180:183], v50, s[32:35], s62 offen offset:1024 sc1
    s_waitcnt vmcnt(10)
    buffer_load_dwordx4 v[184:187], v48, s[32:35], s62 offen offset:2048 sc1
    buffer_load_dwordx4 v[188:191], v49, s[32:35], s62 offen offset:2048 sc1
    buffer_load_dwordx4 v[192:195], v50, s[32:35], s62 offen offset:2048 sc1
    s_waitcnt vmcnt(10)
    buffer_load_dwordx4 v[196:199], v48, s[32:35], s62 offen offset:3072 sc1
    buffer_load_dwordx4 v[200:203], v49, s[32:35], s62 offen offset:3072 sc1
    buffer_load_dwordx4 v[204:207], v50, s[32:35], s62 offen offset:3072 sc1
    s_waitcnt vmcnt(10)
    buffer_load_dwordx4 v[208:211], v48, s[32:35], s63 offen offset:0 sc1
    buffer_load_dwordx4 v[212:215], v49, s[32:35], s63 offen offset:0 sc1
    buffer_load_dwordx4 v[216:219], v50, s[32:35], s63 offen offset:0 sc1
    s_waitcnt vmcnt(10)
    buffer_load_dwordx4 v[220:223], v48, s[32:35], s63 offen offset:1024 sc1
    buffer_load_dwordx4 v[224:227], v49, s[32:35], s63 offen offset:1024 sc1
    buffer_load_dwordx4 v[228:231], v50, s[32:35], s63 offen offset:1024 sc1
    s_waitcnt vmcnt(10)
    buffer_load_dwordx4 v[232:235], v48, s[32:35], s63 offen offset:2048 sc1
    buffer_load_dwordx4 v[236:239], v49, s[32:35], s63 offen offset:2048 sc1
    buffer_load_dwordx4 v[240:243], v50, s[32:35], s63 offen offset:2048 sc1
    s_waitcnt vmcnt(10)
    buffer_load_dwordx4 v[244:247], v48, s[32:35], s63 offen offset:3072 sc1
    buffer_load_dwordx4 v[248:251], v49, s[32:35], s63 offen offset:3072 sc1
    buffer_load_dwordx4 v[252:255], v50, s[32:35], s63 offen offset:3072 sc1
    s_setprio 0
    s_barrier
    ds_read_b128 v[24:27], v61 offset:0
    ds_read_b128 v[28:31], v61 offset:16
    ds_read_b128 v[32:35], v61 offset:32
    s_waitcnt lgkmcnt(2)
    v_mfma_f32_16x16x32_bf16 v[0:3], v[64:67], v[24:27], 0
    ds_read_b128 v[36:39], v61 offset:48
    v_mfma_f32_16x16x32_bf16 v[4:7], v[68:71], v[24:27], 0
    v_mfma_f32_16x16x32_bf16 v[8:11], v[72:75], v[24:27], 0
    s_waitcnt lgkmcnt(2)
    v_mfma_f32_16x16x32_bf16 v[0:3], v[76:79], v[28:31], v[0:3]
    ds_read_b128 v[24:27], v61 offset:64
    v_mfma_f32_16x16x32_bf16 v[4:7], v[80:83], v[28:31], v[4:7]
    v_mfma_f32_16x16x32_bf16 v[8:11], v[84:87], v[28:31], v[8:11]
    s_waitcnt lgkmcnt(2)
    v_mfma_f32_16x16x32_bf16 v[0:3], v[88:91], v[32:35], v[0:3]
    ds_read_b128 v[28:31], v61 offset:80
    v_mfma_f32_16x16x32_bf16 v[4:7], v[92:95], v[32:35], v[4:7]
    v_mfma_f32_16x16x32_bf16 v[8:11], v[96:99], v[32:35], v[8:11]
    s_waitcnt lgkmcnt(2)
    v_mfma_f32_16x16x32_bf16 v[0:3], v[100:103], v[36:39], v[0:3]
    ds_read_b128 v[32:35], v61 offset:96
    v_mfma_f32_16x16x32_bf16 v[4:7], v[104:107], v[36:39], v[4:7]
    v_mfma_f32_16x16x32_bf16 v[8:11], v[108:111], v[36:39], v[8:11]
    s_waitcnt lgkmcnt(2)
    v_mfma_f32_16x16x32_bf16 v[0:3], v[112:115], v[24:27], v[0:3]
    ds_read_b128 v[36:39], v61 offset:112
    v_mfma_f32_16x16x32_bf16 v[4:7], v[116:119], v[24:27], v[4:7]
    v_mfma_f32_16x16x32_bf16 v[8:11], v[120:123], v[24:27], v[8:11]
    s_waitcnt lgkmcnt(2)
    v_mfma_f32_16x16x32_bf16 v[0:3], v[124:127], v[28:31], v[0:3]
    ds_read_b128 v[24:27], v61 offset:128
    v_mfma_f32_16x16x32_bf16 v[4:7], v[128:131], v[28:31], v[4:7]
    v_mfma_f32_16x16x32_bf16 v[8:11], v[132:135], v[28:31], v[8:11]
    s_waitcnt lgkmcnt(2)
    v_mfma_f32_16x16x32_bf16 v[0:3], v[136:139], v[32:35], v[0:3]
    ds_read_b128 v[28:31], v61 offset:144
    v_mfma_f32_16x16x32_bf16 v[4:7], v[140:143], v[32:35], v[4:7]
    v_mfma_f32_16x16x32_bf16 v[8:11], v[144:147], v[32:35], v[8:11]
    s_waitcnt lgkmcnt(2)
    v_mfma_f32_16x16x32_bf16 v[0:3], v[148:151], v[36:39], v[0:3]
    ds_read_b128 v[32:35], v61 offset:160
    v_mfma_f32_16x16x32_bf16 v[4:7], v[152:155], v[36:39], v[4:7]
    v_mfma_f32_16x16x32_bf16 v[8:11], v[156:159], v[36:39], v[8:11]
    s_waitcnt lgkmcnt(2)
    v_mfma_f32_16x16x32_bf16 v[0:3], v[160:163], v[24:27], v[0:3]
    ds_read_b128 v[36:39], v61 offset:176
    v_mfma_f32_16x16x32_bf16 v[4:7], v[164:167], v[24:27], v[4:7]
    v_mfma_f32_16x16x32_bf16 v[8:11], v[168:171], v[24:27], v[8:11]
    s_waitcnt lgkmcnt(2)
    v_mfma_f32_16x16x32_bf16 v[0:3], v[172:175], v[28:31], v[0:3]
    ds_read_b128 v[24:27], v61 offset:192
    v_mfma_f32_16x16x32_bf16 v[4:7], v[176:179], v[28:31], v[4:7]
    v_mfma_f32_16x16x32_bf16 v[8:11], v[180:183], v[28:31], v[8:11]
    s_waitcnt lgkmcnt(2)
    v_mfma_f32_16x16x32_bf16 v[0:3], v[184:187], v[32:35], v[0:3]
    ds_read_b128 v[28:31], v61 offset:208
    v_mfma_f32_16x16x32_bf16 v[4:7], v[188:191], v[32:35], v[4:7]
    v_mfma_f32_16x16x32_bf16 v[8:11], v[192:195], v[32:35], v[8:11]
    s_waitcnt lgkmcnt(2)
    v_mfma_f32_16x16x32_bf16 v[0:3], v[196:199], v[36:39], v[0:3]
    ds_read_b128 v[32:35], v61 offset:224
    v_mfma_f32_16x16x32_bf16 v[4:7], v[200:203], v[36:39], v[4:7]
    s_waitcnt vmcnt(12)
    v_mfma_f32_16x16x32_bf16 v[8:11], v[204:207], v[36:39], v[8:11]
    s_waitcnt lgkmcnt(2)
    s_waitcnt vmcnt(11)
    v_mfma_f32_16x16x32_bf16 v[0:3], v[208:211], v[24:27], v[0:3]
    ds_read_b128 v[36:39], v61 offset:240
    s_waitcnt vmcnt(10)
    v_mfma_f32_16x16x32_bf16 v[4:7], v[212:215], v[24:27], v[4:7]
    s_barrier
    s_waitcnt vmcnt(9)
    v_mfma_f32_16x16x32_bf16 v[8:11], v[216:219], v[24:27], v[8:11]
    s_waitcnt lgkmcnt(2)
    s_waitcnt vmcnt(8)
    v_mfma_f32_16x16x32_bf16 v[0:3], v[220:223], v[28:31], v[0:3]
    ds_read_b128 v[24:27], v61 offset:16640
    s_waitcnt vmcnt(7)
    v_mfma_f32_16x16x32_bf16 v[4:7], v[224:227], v[28:31], v[4:7]
    s_waitcnt vmcnt(6)
    v_mfma_f32_16x16x32_bf16 v[8:11], v[228:231], v[28:31], v[8:11]
    s_waitcnt lgkmcnt(2)
    s_waitcnt vmcnt(5)
    v_mfma_f32_16x16x32_bf16 v[0:3], v[232:235], v[32:35], v[0:3]
    ds_read_b128 v[28:31], v61 offset:16656
    s_waitcnt vmcnt(4)
    v_mfma_f32_16x16x32_bf16 v[4:7], v[236:239], v[32:35], v[4:7]
    s_waitcnt vmcnt(3)
    v_mfma_f32_16x16x32_bf16 v[8:11], v[240:243], v[32:35], v[8:11]
    s_waitcnt lgkmcnt(2)
    s_waitcnt vmcnt(2)
    v_mfma_f32_16x16x32_bf16 v[0:3], v[244:247], v[36:39], v[0:3]
    ds_read_b128 v[32:35], v61 offset:16672
    s_waitcnt vmcnt(1)
    v_mfma_f32_16x16x32_bf16 v[4:7], v[248:251], v[36:39], v[4:7]
    s_waitcnt vmcnt(0)
    v_mfma_f32_16x16x32_bf16 v[8:11], v[252:255], v[36:39], v[8:11]
    s_waitcnt lgkmcnt(2)
    v_mfma_f32_16x16x32_bf16 v[12:15], v[64:67], v[24:27], 0
    ds_read_b128 v[36:39], v61 offset:16688
    v_mfma_f32_16x16x32_bf16 v[16:19], v[68:71], v[24:27], 0
    v_exp_f32 v48, -v0
    v_mfma_f32_16x16x32_bf16 v[20:23], v[72:75], v[24:27], 0
    s_waitcnt lgkmcnt(2)
    v_exp_f32 v49, -v1
    v_mfma_f32_16x16x32_bf16 v[12:15], v[76:79], v[28:31], v[12:15]
    ds_read_b128 v[24:27], v61 offset:16704
    v_add_f32 v48, 1.0, v48
    v_mfma_f32_16x16x32_bf16 v[16:19], v[80:83], v[28:31], v[16:19]
    v_rcp_f32 v48, v48
    v_mfma_f32_16x16x32_bf16 v[20:23], v[84:87], v[28:31], v[20:23]
    s_waitcnt lgkmcnt(2)
    v_exp_f32 v50, -v2
    v_mfma_f32_16x16x32_bf16 v[12:15], v[88:91], v[32:35], v[12:15]
    ds_read_b128 v[28:31], v61 offset:16720
    v_mul_f32 v48, v48, v0
    v_mfma_f32_16x16x32_bf16 v[16:19], v[92:95], v[32:35], v[16:19]
    v_exp_f32 v51, -v3
    v_mfma_f32_16x16x32_bf16 v[20:23], v[96:99], v[32:35], v[20:23]
    s_waitcnt lgkmcnt(2)
    v_exp_f32 v52, -v4
    v_mfma_f32_16x16x32_bf16 v[12:15], v[100:103], v[36:39], v[12:15]
    ds_read_b128 v[32:35], v61 offset:16736
    v_add_f32 v49, 1.0, v49
    v_add_f32 v50, 1.0, v50
    v_mfma_f32_16x16x32_bf16 v[16:19], v[104:107], v[36:39], v[16:19]
    v_rcp_f32 v49, v49
    v_mfma_f32_16x16x32_bf16 v[20:23], v[108:111], v[36:39], v[20:23]
    s_waitcnt lgkmcnt(2)
    v_rcp_f32 v50, v50
    v_mfma_f32_16x16x32_bf16 v[12:15], v[112:115], v[24:27], v[12:15]
    ds_read_b128 v[36:39], v61 offset:16752
    v_mul_f32 v49, v49, v1
    v_mul_f32 v50, v50, v2
    v_mfma_f32_16x16x32_bf16 v[16:19], v[116:119], v[24:27], v[16:19]
    v_exp_f32 v53, -v5
    v_mfma_f32_16x16x32_bf16 v[20:23], v[120:123], v[24:27], v[20:23]
    s_waitcnt lgkmcnt(2)
    v_exp_f32 v54, -v6
    v_mfma_f32_16x16x32_bf16 v[12:15], v[124:127], v[28:31], v[12:15]
    ds_read_b128 v[24:27], v61 offset:16768
    v_cvt_pk_bf16_f32 v40, v48, v49
    v_add_f32 v51, 1.0, v51
    v_mfma_f32_16x16x32_bf16 v[16:19], v[128:131], v[28:31], v[16:19]
    v_rcp_f32 v51, v51
    v_mfma_f32_16x16x32_bf16 v[20:23], v[132:135], v[28:31], v[20:23]
    s_waitcnt lgkmcnt(2)
    v_exp_f32 v55, -v7
    v_mfma_f32_16x16x32_bf16 v[12:15], v[136:139], v[32:35], v[12:15]
    ds_read_b128 v[28:31], v61 offset:16784
    v_mul_f32 v51, v51, v3
    v_add_f32 v52, 1.0, v52
    v_mfma_f32_16x16x32_bf16 v[16:19], v[140:143], v[32:35], v[16:19]
    v_rcp_f32 v52, v52
    v_mfma_f32_16x16x32_bf16 v[20:23], v[144:147], v[32:35], v[20:23]
    s_waitcnt lgkmcnt(2)
    v_exp_f32 v56, -v8
    v_mfma_f32_16x16x32_bf16 v[12:15], v[148:151], v[36:39], v[12:15]
    ds_read_b128 v[32:35], v61 offset:16800
    v_cvt_pk_bf16_f32 v41, v50, v51
    v_mul_f32 v52, v52, v4
    v_mfma_f32_16x16x32_bf16 v[16:19], v[152:155], v[36:39], v[16:19]
    v_exp_f32 v57, -v9
    v_mfma_f32_16x16x32_bf16 v[20:23], v[156:159], v[36:39], v[20:23]
    s_waitcnt lgkmcnt(2)
    v_exp_f32 v58, -v10
    v_mfma_f32_16x16x32_bf16 v[12:15], v[160:163], v[24:27], v[12:15]
    ds_read_b128 v[36:39], v61 offset:16816
    v_add_f32 v53, 1.0, v53
    v_mfma_f32_16x16x32_bf16 v[16:19], v[164:167], v[24:27], v[16:19]
    v_rcp_f32 v53, v53
    v_mfma_f32_16x16x32_bf16 v[20:23], v[168:171], v[24:27], v[20:23]
    s_waitcnt lgkmcnt(2)
    v_exp_f32 v59, -v11
    v_mfma_f32_16x16x32_bf16 v[12:15], v[172:175], v[28:31], v[12:15]
    ds_read_b128 v[24:27], v61 offset:16832
    v_mul_f32 v53, v53, v5
    v_add_f32 v54, 1.0, v54
    v_mfma_f32_16x16x32_bf16 v[16:19], v[176:179], v[28:31], v[16:19]
    v_rcp_f32 v54, v54
    v_mfma_f32_16x16x32_bf16 v[20:23], v[180:183], v[28:31], v[20:23]
    s_waitcnt lgkmcnt(2)
    v_cvt_pk_bf16_f32 v42, v52, v53
    v_mul_f32 v54, v54, v6
    v_mfma_f32_16x16x32_bf16 v[12:15], v[184:187], v[32:35], v[12:15]
    ds_read_b128 v[28:31], v61 offset:16848
    v_add_f32 v55, 1.0, v55
    v_add_f32 v56, 1.0, v56
    v_mfma_f32_16x16x32_bf16 v[16:19], v[188:191], v[32:35], v[16:19]
    v_permlane32_swap_b32 v40, v42
    v_mfma_f32_16x16x32_bf16 v[20:23], v[192:195], v[32:35], v[20:23]
    s_waitcnt lgkmcnt(2)
    v_rcp_f32 v55, v55
    v_mfma_f32_16x16x32_bf16 v[12:15], v[196:199], v[36:39], v[12:15]
    ds_read_b128 v[32:35], v61 offset:16864
    v_mul_f32 v55, v55, v7
    v_add_f32 v57, 1.0, v57
    v_mfma_f32_16x16x32_bf16 v[16:19], v[200:203], v[36:39], v[16:19]
    v_rcp_f32 v56, v56
    v_mfma_f32_16x16x32_bf16 v[20:23], v[204:207], v[36:39], v[20:23]
    s_waitcnt lgkmcnt(2)
    v_rcp_f32 v57, v57
    v_mfma_f32_16x16x32_bf16 v[12:15], v[208:211], v[24:27], v[12:15]
    ds_read_b128 v[36:39], v61 offset:16880
    v_cvt_pk_bf16_f32 v43, v54, v55
    v_mul_f32 v56, v56, v8
    v_mfma_f32_16x16x32_bf16 v[16:19], v[212:215], v[24:27], v[16:19]
    v_permlane32_swap_b32 v41, v43
    v_mfma_f32_16x16x32_bf16 v[20:23], v[216:219], v[24:27], v[20:23]
    s_waitcnt lgkmcnt(2)
    v_mul_f32 v57, v57, v9
    v_add_f32 v58, 1.0, v58
    v_mfma_f32_16x16x32_bf16 v[12:15], v[220:223], v[28:31], v[12:15]
    ds_read_b128 v[24:27], v61 offset:33280
    v_cvt_pk_bf16_f32 v44, v56, v57
    v_add_f32 v59, 1.0, v59
    v_mfma_f32_16x16x32_bf16 v[16:19], v[224:227], v[28:31], v[16:19]
    v_permlane32_swap_b32 v44, v46
    v_mfma_f32_16x16x32_bf16 v[20:23], v[228:231], v[28:31], v[20:23]
    s_waitcnt lgkmcnt(2)
    v_rcp_f32 v58, v58
    v_mfma_f32_16x16x32_bf16 v[12:15], v[232:235], v[32:35], v[12:15]
    ds_read_b128 v[28:31], v61 offset:33296
    v_rcp_f32 v59, v59
    v_mfma_f32_16x16x32_bf16 v[16:19], v[236:239], v[32:35], v[16:19]
    v_mul_f32 v58, v58, v10
    v_mul_f32 v59, v59, v11
    v_mfma_f32_16x16x32_bf16 v[20:23], v[240:243], v[32:35], v[20:23]
    s_waitcnt lgkmcnt(2)
    v_cvt_pk_bf16_f32 v45, v58, v59
    v_mfma_f32_16x16x32_bf16 v[12:15], v[244:247], v[36:39], v[12:15]
    ds_read_b128 v[32:35], v61 offset:33312
    v_permlane32_swap_b32 v45, v47
    v_mfma_f32_16x16x32_bf16 v[16:19], v[248:251], v[36:39], v[16:19]
    buffer_store_dwordx4 v[40:43], v62, s[32:35], s56 offen sc1
    v_mfma_f32_16x16x32_bf16 v[20:23], v[252:255], v[36:39], v[20:23]
    s_waitcnt lgkmcnt(2)
    buffer_store_dwordx4 v[44:47], v63, s[32:35], s56 offen sc1
    v_mfma_f32_16x16x32_bf16 v[0:3], v[64:67], v[24:27], 0
    ds_read_b128 v[36:39], v61 offset:33328
    v_mfma_f32_16x16x32_bf16 v[4:7], v[68:71], v[24:27], 0
    v_exp_f32 v48, -v12
    v_mfma_f32_16x16x32_bf16 v[8:11], v[72:75], v[24:27], 0
    s_waitcnt lgkmcnt(2)
    v_exp_f32 v49, -v13
    v_mfma_f32_16x16x32_bf16 v[0:3], v[76:79], v[28:31], v[0:3]
    ds_read_b128 v[24:27], v61 offset:33344
    v_add_f32 v48, 1.0, v48
    v_mfma_f32_16x16x32_bf16 v[4:7], v[80:83], v[28:31], v[4:7]
    v_rcp_f32 v48, v48
    v_mfma_f32_16x16x32_bf16 v[8:11], v[84:87], v[28:31], v[8:11]
    s_waitcnt lgkmcnt(2)
    v_exp_f32 v50, -v14
    v_mfma_f32_16x16x32_bf16 v[0:3], v[88:91], v[32:35], v[0:3]
    ds_read_b128 v[28:31], v61 offset:33360
    v_mul_f32 v48, v48, v12
    v_mfma_f32_16x16x32_bf16 v[4:7], v[92:95], v[32:35], v[4:7]
    v_exp_f32 v51, -v15
    v_mfma_f32_16x16x32_bf16 v[8:11], v[96:99], v[32:35], v[8:11]
    s_waitcnt lgkmcnt(2)
    v_exp_f32 v52, -v16
    v_mfma_f32_16x16x32_bf16 v[0:3], v[100:103], v[36:39], v[0:3]
    ds_read_b128 v[32:35], v61 offset:33376
    v_add_f32 v49, 1.0, v49
    v_add_f32 v50, 1.0, v50
    v_mfma_f32_16x16x32_bf16 v[4:7], v[104:107], v[36:39], v[4:7]
    v_rcp_f32 v49, v49
    v_mfma_f32_16x16x32_bf16 v[8:11], v[108:111], v[36:39], v[8:11]
    s_waitcnt lgkmcnt(2)
    v_rcp_f32 v50, v50
    v_mfma_f32_16x16x32_bf16 v[0:3], v[112:115], v[24:27], v[0:3]
    ds_read_b128 v[36:39], v61 offset:33392
    v_mul_f32 v49, v49, v13
    v_mul_f32 v50, v50, v14
    v_mfma_f32_16x16x32_bf16 v[4:7], v[116:119], v[24:27], v[4:7]
    v_exp_f32 v53, -v17
    v_mfma_f32_16x16x32_bf16 v[8:11], v[120:123], v[24:27], v[8:11]
    s_waitcnt lgkmcnt(2)
    v_exp_f32 v54, -v18
    v_mfma_f32_16x16x32_bf16 v[0:3], v[124:127], v[28:31], v[0:3]
    ds_read_b128 v[24:27], v61 offset:33408
    v_cvt_pk_bf16_f32 v40, v48, v49
    v_add_f32 v51, 1.0, v51
    v_mfma_f32_16x16x32_bf16 v[4:7], v[128:131], v[28:31], v[4:7]
    v_rcp_f32 v51, v51
    v_mfma_f32_16x16x32_bf16 v[8:11], v[132:135], v[28:31], v[8:11]
    s_waitcnt lgkmcnt(2)
    v_exp_f32 v55, -v19
    v_mfma_f32_16x16x32_bf16 v[0:3], v[136:139], v[32:35], v[0:3]
    ds_read_b128 v[28:31], v61 offset:33424
    v_mul_f32 v51, v51, v15
    v_add_f32 v52, 1.0, v52
    v_mfma_f32_16x16x32_bf16 v[4:7], v[140:143], v[32:35], v[4:7]
    v_rcp_f32 v52, v52
    v_mfma_f32_16x16x32_bf16 v[8:11], v[144:147], v[32:35], v[8:11]
    s_waitcnt lgkmcnt(2)
    v_exp_f32 v56, -v20
    v_mfma_f32_16x16x32_bf16 v[0:3], v[148:151], v[36:39], v[0:3]
    ds_read_b128 v[32:35], v61 offset:33440
    v_cvt_pk_bf16_f32 v41, v50, v51
    v_mul_f32 v52, v52, v16
    v_mfma_f32_16x16x32_bf16 v[4:7], v[152:155], v[36:39], v[4:7]
    v_exp_f32 v57, -v21
    v_mfma_f32_16x16x32_bf16 v[8:11], v[156:159], v[36:39], v[8:11]
    s_waitcnt lgkmcnt(2)
    v_exp_f32 v58, -v22
    v_mfma_f32_16x16x32_bf16 v[0:3], v[160:163], v[24:27], v[0:3]
    ds_read_b128 v[36:39], v61 offset:33456
    v_add_f32 v53, 1.0, v53
    v_mfma_f32_16x16x32_bf16 v[4:7], v[164:167], v[24:27], v[4:7]
    v_rcp_f32 v53, v53
    v_mfma_f32_16x16x32_bf16 v[8:11], v[168:171], v[24:27], v[8:11]
    s_waitcnt lgkmcnt(2)
    v_exp_f32 v59, -v23
    v_mfma_f32_16x16x32_bf16 v[0:3], v[172:175], v[28:31], v[0:3]
    ds_read_b128 v[24:27], v61 offset:33472
    v_mul_f32 v53, v53, v17
    v_add_f32 v54, 1.0, v54
    v_mfma_f32_16x16x32_bf16 v[4:7], v[176:179], v[28:31], v[4:7]
    v_rcp_f32 v54, v54
    v_mfma_f32_16x16x32_bf16 v[8:11], v[180:183], v[28:31], v[8:11]
    s_waitcnt lgkmcnt(2)
    v_cvt_pk_bf16_f32 v42, v52, v53
    v_mul_f32 v54, v54, v18
    v_mfma_f32_16x16x32_bf16 v[0:3], v[184:187], v[32:35], v[0:3]
    ds_read_b128 v[28:31], v61 offset:33488
    v_add_f32 v55, 1.0, v55
    v_add_f32 v56, 1.0, v56
    v_mfma_f32_16x16x32_bf16 v[4:7], v[188:191], v[32:35], v[4:7]
    v_permlane32_swap_b32 v40, v42
    v_mfma_f32_16x16x32_bf16 v[8:11], v[192:195], v[32:35], v[8:11]
    s_waitcnt lgkmcnt(2)
    v_rcp_f32 v55, v55
    v_mfma_f32_16x16x32_bf16 v[0:3], v[196:199], v[36:39], v[0:3]
    ds_read_b128 v[32:35], v61 offset:33504
    v_mul_f32 v55, v55, v19
    v_add_f32 v57, 1.0, v57
    v_mfma_f32_16x16x32_bf16 v[4:7], v[200:203], v[36:39], v[4:7]
    v_rcp_f32 v56, v56
    v_mfma_f32_16x16x32_bf16 v[8:11], v[204:207], v[36:39], v[8:11]
    s_waitcnt lgkmcnt(2)
    v_rcp_f32 v57, v57
    v_mfma_f32_16x16x32_bf16 v[0:3], v[208:211], v[24:27], v[0:3]
    ds_read_b128 v[36:39], v61 offset:33520
    v_cvt_pk_bf16_f32 v43, v54, v55
    v_mul_f32 v56, v56, v20
    v_mfma_f32_16x16x32_bf16 v[4:7], v[212:215], v[24:27], v[4:7]
    v_permlane32_swap_b32 v41, v43
    v_mfma_f32_16x16x32_bf16 v[8:11], v[216:219], v[24:27], v[8:11]
    s_waitcnt lgkmcnt(2)
    v_mul_f32 v57, v57, v21
    v_add_f32 v58, 1.0, v58
    v_mfma_f32_16x16x32_bf16 v[0:3], v[220:223], v[28:31], v[0:3]
    ds_read_b128 v[24:27], v61 offset:49920
    v_cvt_pk_bf16_f32 v44, v56, v57
    v_add_f32 v59, 1.0, v59
    v_mfma_f32_16x16x32_bf16 v[4:7], v[224:227], v[28:31], v[4:7]
    v_permlane32_swap_b32 v44, v46
    v_mfma_f32_16x16x32_bf16 v[8:11], v[228:231], v[28:31], v[8:11]
    s_waitcnt lgkmcnt(2)
    v_rcp_f32 v58, v58
    v_mfma_f32_16x16x32_bf16 v[0:3], v[232:235], v[32:35], v[0:3]
    ds_read_b128 v[28:31], v61 offset:49936
    v_rcp_f32 v59, v59
    v_mfma_f32_16x16x32_bf16 v[4:7], v[236:239], v[32:35], v[4:7]
    v_mul_f32 v58, v58, v22
    v_mul_f32 v59, v59, v23
    v_mfma_f32_16x16x32_bf16 v[8:11], v[240:243], v[32:35], v[8:11]
    s_waitcnt lgkmcnt(2)
    v_cvt_pk_bf16_f32 v45, v58, v59
    v_mfma_f32_16x16x32_bf16 v[0:3], v[244:247], v[36:39], v[0:3]
    ds_read_b128 v[32:35], v61 offset:49952
    v_permlane32_swap_b32 v45, v47
    v_mfma_f32_16x16x32_bf16 v[4:7], v[248:251], v[36:39], v[4:7]
    buffer_store_dwordx4 v[40:43], v62, s[32:35], s57 offen sc1
    v_mfma_f32_16x16x32_bf16 v[8:11], v[252:255], v[36:39], v[8:11]
    s_waitcnt lgkmcnt(2)
    buffer_store_dwordx4 v[44:47], v63, s[32:35], s57 offen sc1
    v_mfma_f32_16x16x32_bf16 v[12:15], v[64:67], v[24:27], 0
    ds_read_b128 v[36:39], v61 offset:49968
    v_mfma_f32_16x16x32_bf16 v[16:19], v[68:71], v[24:27], 0
    v_exp_f32 v48, -v0
    v_mfma_f32_16x16x32_bf16 v[20:23], v[72:75], v[24:27], 0
    s_waitcnt lgkmcnt(2)
    v_exp_f32 v49, -v1
    v_mfma_f32_16x16x32_bf16 v[12:15], v[76:79], v[28:31], v[12:15]
    ds_read_b128 v[24:27], v61 offset:49984
    v_add_f32 v48, 1.0, v48
    v_mfma_f32_16x16x32_bf16 v[16:19], v[80:83], v[28:31], v[16:19]
    ds_write_b32 v60, v60
    v_add_f32 v49, 1.0, v49
    v_mfma_f32_16x16x32_bf16 v[20:23], v[84:87], v[28:31], v[20:23]
    s_waitcnt lgkmcnt(3)
    v_rcp_f32 v48, v48
    v_mfma_f32_16x16x32_bf16 v[12:15], v[88:91], v[32:35], v[12:15]
    ds_read_b128 v[28:31], v61 offset:50000
    v_rcp_f32 v49, v49
    v_mfma_f32_16x16x32_bf16 v[16:19], v[92:95], v[32:35], v[16:19]
    v_exp_f32 v50, -v2
    v_mfma_f32_16x16x32_bf16 v[20:23], v[96:99], v[32:35], v[20:23]
    s_waitcnt lgkmcnt(3)
    v_exp_f32 v51, -v3
    v_mfma_f32_16x16x32_bf16 v[12:15], v[100:103], v[36:39], v[12:15]
    ds_read_b128 v[32:35], v61 offset:50016
    v_mul_f32 v48, v48, v0
    v_mfma_f32_16x16x32_bf16 v[16:19], v[104:107], v[36:39], v[16:19]
    v_exp_f32 v52, -v4
    v_mfma_f32_16x16x32_bf16 v[20:23], v[108:111], v[36:39], v[20:23]
    s_waitcnt lgkmcnt(3)
    v_exp_f32 v53, -v5
    v_mfma_f32_16x16x32_bf16 v[12:15], v[112:115], v[24:27], v[12:15]
    ds_read_b128 v[36:39], v61 offset:50032
    v_mul_f32 v49, v49, v1
    v_add_f32 v50, 1.0, v50
    v_mfma_f32_16x16x32_bf16 v[16:19], v[116:119], v[24:27], v[16:19]
    v_rcp_f32 v50, v50
    v_mfma_f32_16x16x32_bf16 v[20:23], v[120:123], v[24:27], v[20:23]
    s_waitcnt lgkmcnt(2)
    v_exp_f32 v54, -v6
    v_mfma_f32_16x16x32_bf16 v[12:15], v[124:127], v[28:31], v[12:15]
    ds_read_b128 v[24:27], v61 offset:50048
    v_cvt_pk_bf16_f32 v40, v48, v49
    v_mul_f32 v50, v50, v2
    v_mfma_f32_16x16x32_bf16 v[16:19], v[128:131], v[28:31], v[16:19]
    v_exp_f32 v55, -v7
    v_mfma_f32_16x16x32_bf16 v[20:23], v[132:135], v[28:31], v[20:23]
    s_waitcnt lgkmcnt(2)
    v_exp_f32 v56, -v8
    v_mfma_f32_16x16x32_bf16 v[12:15], v[136:139], v[32:35], v[12:15]
    ds_read_b128 v[28:31], v61 offset:50064
    v_add_f32 v51, 1.0, v51
    v_add_f32 v52, 1.0, v52
    v_mfma_f32_16x16x32_bf16 v[16:19], v[140:143], v[32:35], v[16:19]
    v_rcp_f32 v51, v51
    v_mfma_f32_16x16x32_bf16 v[20:23], v[144:147], v[32:35], v[20:23]
    s_waitcnt lgkmcnt(2)
    v_rcp_f32 v52, v52
    v_mfma_f32_16x16x32_bf16 v[12:15], v[148:151], v[36:39], v[12:15]
    ds_read_b128 v[32:35], v61 offset:50080
    v_mul_f32 v51, v51, v3
    v_mul_f32 v52, v52, v4
    v_mfma_f32_16x16x32_bf16 v[16:19], v[152:155], v[36:39], v[16:19]
    v_exp_f32 v57, -v9
    v_mfma_f32_16x16x32_bf16 v[20:23], v[156:159], v[36:39], v[20:23]
    s_waitcnt lgkmcnt(2)
    v_exp_f32 v58, -v10
    v_mfma_f32_16x16x32_bf16 v[12:15], v[160:163], v[24:27], v[12:15]
    ds_read_b128 v[36:39], v61 offset:50096
    v_cvt_pk_bf16_f32 v41, v50, v51
    v_mfma_f32_16x16x32_bf16 v[16:19], v[164:167], v[24:27], v[16:19]
    v_exp_f32 v59, -v11
    v_mfma_f32_16x16x32_bf16 v[20:23], v[168:171], v[24:27], v[20:23]
    s_waitcnt lgkmcnt(2)
    v_add_f32 v53, 1.0, v53
    v_add_f32 v54, 1.0, v54
    v_mfma_f32_16x16x32_bf16 v[12:15], v[172:175], v[28:31], v[12:15]
    ds_read_b128 v[24:27], v61 offset:50112
    v_add_f32 v55, 1.0, v55
    v_add_f32 v56, 1.0, v56
    v_mfma_f32_16x16x32_bf16 v[16:19], v[176:179], v[28:31], v[16:19]
    v_rcp_f32 v53, v53
    v_mfma_f32_16x16x32_bf16 v[20:23], v[180:183], v[28:31], v[20:23]
    s_waitcnt lgkmcnt(2)
    v_rcp_f32 v54, v54
    v_mfma_f32_16x16x32_bf16 v[12:15], v[184:187], v[32:35], v[12:15]
    ds_read_b128 v[28:31], v61 offset:50128
    v_mul_f32 v53, v53, v5
    v_mul_f32 v54, v54, v6
    v_mfma_f32_16x16x32_bf16 v[16:19], v[188:191], v[32:35], v[16:19]
    v_rcp_f32 v55, v55
    v_mfma_f32_16x16x32_bf16 v[20:23], v[192:195], v[32:35], v[20:23]
    s_waitcnt lgkmcnt(2)
    v_rcp_f32 v56, v56
    v_mfma_f32_16x16x32_bf16 v[12:15], v[196:199], v[36:39], v[12:15]
    ds_read_b128 v[32:35], v61 offset:50144
    v_cvt_pk_bf16_f32 v42, v52, v53
    v_mul_f32 v55, v55, v7
    v_mfma_f32_16x16x32_bf16 v[16:19], v[200:203], v[36:39], v[16:19]
    v_permlane32_swap_b32 v40, v42
    v_mfma_f32_16x16x32_bf16 v[20:23], v[204:207], v[36:39], v[20:23]
    s_waitcnt lgkmcnt(2)
    v_cvt_pk_bf16_f32 v43, v54, v55
    v_mul_f32 v56, v56, v8
    v_mfma_f32_16x16x32_bf16 v[12:15], v[208:211], v[24:27], v[12:15]
    ds_read_b128 v[36:39], v61 offset:50160
    v_add_f32 v57, 1.0, v57
    v_add_f32 v58, 1.0, v58
    v_mfma_f32_16x16x32_bf16 v[16:19], v[212:215], v[24:27], v[16:19]
    v_permlane32_swap_b32 v41, v43
    v_mfma_f32_16x16x32_bf16 v[20:23], v[216:219], v[24:27], v[20:23]
    s_waitcnt lgkmcnt(2)
    v_rcp_f32 v57, v57
    v_mfma_f32_16x16x32_bf16 v[12:15], v[220:223], v[28:31], v[12:15]
    v_rcp_f32 v58, v58
    v_mfma_f32_16x16x32_bf16 v[16:19], v[224:227], v[28:31], v[16:19]
    v_mul_f32 v57, v57, v9
    v_mul_f32 v58, v58, v10
    v_mfma_f32_16x16x32_bf16 v[20:23], v[228:231], v[28:31], v[20:23]
    s_waitcnt lgkmcnt(1)
    v_cvt_pk_bf16_f32 v44, v56, v57
    v_add_f32 v59, 1.0, v59
    v_mfma_f32_16x16x32_bf16 v[12:15], v[232:235], v[32:35], v[12:15]
    v_permlane32_swap_b32 v44, v46
    v_mfma_f32_16x16x32_bf16 v[16:19], v[236:239], v[32:35], v[16:19]
    v_rcp_f32 v59, v59
    v_mfma_f32_16x16x32_bf16 v[20:23], v[240:243], v[32:35], v[20:23]
    s_waitcnt lgkmcnt(0)
    v_mul_f32 v59, v59, v11
    v_mfma_f32_16x16x32_bf16 v[12:15], v[244:247], v[36:39], v[12:15]
    v_cvt_pk_bf16_f32 v45, v58, v59
    v_mfma_f32_16x16x32_bf16 v[16:19], v[248:251], v[36:39], v[16:19]
    buffer_store_dwordx4 v[40:43], v62, s[32:35], s58 offen sc1
    v_permlane32_swap_b32 v45, v47
    v_mfma_f32_16x16x32_bf16 v[20:23], v[252:255], v[36:39], v[20:23]
    buffer_store_dwordx4 v[44:47], v63, s[32:35], s58 offen sc1
    s_nop 1
    v_exp_f32 v48, -v12
    v_exp_f32 v49, -v13
    v_exp_f32 v50, -v14
    v_exp_f32 v51, -v15
    v_exp_f32 v52, -v16
    v_exp_f32 v53, -v17
    v_exp_f32 v54, -v18
    v_exp_f32 v55, -v19
    v_exp_f32 v56, -v20
    v_exp_f32 v57, -v21
    v_exp_f32 v58, -v22
    v_exp_f32 v59, -v23
    v_add_f32 v48, 1.0, v48
    v_add_f32 v49, 1.0, v49
    v_add_f32 v50, 1.0, v50
    v_add_f32 v51, 1.0, v51
    v_add_f32 v52, 1.0, v52
    v_add_f32 v53, 1.0, v53
    v_add_f32 v54, 1.0, v54
    v_add_f32 v55, 1.0, v55
    v_add_f32 v56, 1.0, v56
    v_add_f32 v57, 1.0, v57
    v_add_f32 v58, 1.0, v58
    v_add_f32 v59, 1.0, v59
    v_rcp_f32 v48, v48
    v_rcp_f32 v49, v49
    v_rcp_f32 v50, v50
    v_rcp_f32 v51, v51
    v_rcp_f32 v52, v52
    v_rcp_f32 v53, v53
    v_rcp_f32 v54, v54
    v_rcp_f32 v55, v55
    v_rcp_f32 v56, v56
    v_rcp_f32 v57, v57
    v_rcp_f32 v58, v58
    v_rcp_f32 v59, v59
    v_mul_f32 v48, v48, v12
    v_mul_f32 v49, v49, v13
    v_mul_f32 v50, v50, v14
    v_mul_f32 v51, v51, v15
    v_mul_f32 v52, v52, v16
    v_mul_f32 v53, v53, v17
    v_mul_f32 v54, v54, v18
    v_mul_f32 v55, v55, v19
    v_mul_f32 v56, v56, v20
    v_mul_f32 v57, v57, v21
    v_mul_f32 v58, v58, v22
    v_mul_f32 v59, v59, v23
    v_cvt_pk_bf16_f32 v40, v48, v49
    v_cvt_pk_bf16_f32 v41, v50, v51
    v_cvt_pk_bf16_f32 v42, v52, v53
    v_cvt_pk_bf16_f32 v43, v54, v55
    v_cvt_pk_bf16_f32 v44, v56, v57
    v_cvt_pk_bf16_f32 v45, v58, v59
    v_permlane32_swap_b32 v40, v42
    v_permlane32_swap_b32 v41, v43
    v_permlane32_swap_b32 v44, v46
    v_permlane32_swap_b32 v45, v47
    buffer_store_dwordx4 v[40:43], v62, s[32:35], s59 offen sc1
    buffer_store_dwordx4 v[44:47], v63, s[32:35], s59 offen sc1
    s_setprio 2
    v_mbcnt_lo_u32_b32 v64, -1, 0
    v_mbcnt_hi_u32_b32 v64, -1, v64
    v_and_b32 v65, 15, v64
    v_lshrrev_b32 v66, 4, v64
    s_lshl_b32 s37, s38, 4
    s_and_b32 s42, s39, 15
    s_or_b32 s37, s37, s42
    s_and_b32 s42, s2, 0x80
    s_or_b32 s37, s37, s42
    s_mov_b32 s30, 0x200000
    s_mov_b32 s31, 0x20000
    s_lshl_b32 s42, s36, 2
    s_mov_b32 s43, 66560
    v_add_u32 v69, s42, v66
    v_and_b32 v67, 7, v69
    v_xor_b32 v67, v67, v65
    v_lshl_add_u32 v67, v67, 4, s43
    v_lshl_add_u32 v69, v69, 8, v67
    s_lshl_b32 s43, s40, 7
    v_lshl_add_u32 v67, v65, 3, s43
    v_lshl_add_u32 v70, v66, 18, v67
    s_lshl_b32 s43, s41, 4
    s_mul_i32 s42, s36, 4160
    v_xor_b32 v67, s43, v67
    v_mul_u32_u24 v71, 1040, v66
    v_add3_u32 v71, v71, v67, s42
    s_lshr_b32 s42, s50, 3
    s_lshl_b32 s42, s42, 12
    s_lshl_b32 s43, s36, 8
    s_add_u32 s42, s42, s43
    s_add_u32 s42, s42, 6291456
    v_and_b32 v67, 3, v65
    v_lshl_add_u32 v67, v67, 10, s42
    v_lshl_add_u32 v72, v66, 6, v67
    s_and_b32 s42, s37, 0xf8
    s_lshr_b32 s43, s36, 1
    s_add_u32 s42, s42, s43
    s_lshl_b32 s42, s42, 10
    s_and_b32 s43, s36, 1
    s_lshl_b32 s43, s43, 20
    s_add_u32 s58, s42, s43
    s_add_u32 s59, s58, 4096
    s_mov_b32 s54, 0x3f317218
    buffer_load_dwordx2 v[74:75], v72, s[32:35], 0 offen sc1
    ds_read_b64 v[78:79], v71 offset:0
    ds_read_b64 v[80:81], v71 offset:16640
    ds_read_b64 v[82:83], v71 offset:33280
    ds_read_b64 v[84:85], v71 offset:49920
    v_mov_b32 v68, 0
    v_mov_b32 v118, s54
    s_barrier
    ds_read_b128 v[102:105], v69 offset:0
    ds_read_b128 v[106:109], v69 offset:4096
    ds_read_b128 v[110:113], v69 offset:8192
    ds_read_b128 v[114:117], v69 offset:12288
    s_waitcnt vmcnt(0)
    v_mov_b32_dpp v120, v74 row_newbcast:0 row_mask:0xf bank_mask:0xf
    v_mov_b32_dpp v121, v75 row_newbcast:0 row_mask:0xf bank_mask:0xf
    s_waitcnt lgkmcnt(7)
    v_lshlrev_b32 v86, 16, v78
    v_and_b32 v87, 0xffff0000, v78
    v_lshlrev_b32 v88, 16, v79
    v_and_b32 v89, 0xffff0000, v79
    v_fma_f32 v86, v86, v120, v121
    v_fma_f32 v87, v87, v120, v121
    v_fma_f32 v88, v88, v120, v121
    v_fma_f32 v89, v89, v120, v121
    s_waitcnt lgkmcnt(3)
    v_fmac_f32 v86, s54, v102
    v_fmac_f32 v87, s54, v103
    v_fmac_f32 v88, s54, v104
    v_fmac_f32 v89, s54, v105
    s_waitcnt lgkmcnt(2)
    v_fmac_f32 v86, s54, v106
    v_fmac_f32 v87, s54, v107
    v_fmac_f32 v88, s54, v108
    v_fmac_f32 v89, s54, v109
    s_waitcnt lgkmcnt(1)
    v_fmac_f32 v86, s54, v110
    v_fmac_f32 v87, s54, v111
    v_fmac_f32 v88, s54, v112
    v_fmac_f32 v89, s54, v113
    s_waitcnt lgkmcnt(0)
    v_fmac_f32 v86, s54, v114
    v_fmac_f32 v87, s54, v115
    v_fmac_f32 v88, s54, v116
    v_fmac_f32 v89, s54, v117
    v_cvt_pk_bf16_f32 v78, v86, v87
    v_cvt_pk_bf16_f32 v79, v88, v89
    buffer_store_dwordx2 v[78:79], v70, s[28:31], s58 offen offset:0 sc1
    v_mov_b32_dpp v120, v74 row_newbcast:1 row_mask:0xf bank_mask:0xf
    v_mov_b32_dpp v121, v75 row_newbcast:1 row_mask:0xf bank_mask:0xf
    v_lshlrev_b32 v86, 16, v80
    v_and_b32 v87, 0xffff0000, v80
    v_lshlrev_b32 v88, 16, v81
    v_and_b32 v89, 0xffff0000, v81
    v_fma_f32 v86, v86, v120, v121
    v_fma_f32 v87, v87, v120, v121
    v_fma_f32 v88, v88, v120, v121
    v_fma_f32 v89, v89, v120, v121
    s_barrier
    ds_read_b128 v[102:105], v69 offset:16384
    ds_read_b128 v[106:109], v69 offset:20480
    ds_read_b128 v[110:113], v69 offset:24576
    ds_read_b128 v[114:117], v69 offset:28672
    s_waitcnt lgkmcnt(3)
    v_fmac_f32 v86, s54, v102
    v_fmac_f32 v87, s54, v103
    v_fmac_f32 v88, s54, v104
    v_fmac_f32 v89, s54, v105
    s_waitcnt lgkmcnt(2)
    v_fmac_f32 v86, s54, v106
    v_fmac_f32 v87, s54, v107
    v_fmac_f32 v88, s54, v108
    v_fmac_f32 v89, s54, v109
    s_waitcnt lgkmcnt(1)
    v_fmac_f32 v86, s54, v110
    v_fmac_f32 v87, s54, v111
    v_fmac_f32 v88, s54, v112
    v_fmac_f32 v89, s54, v113
    s_waitcnt lgkmcnt(0)
    v_fmac_f32 v86, s54, v114
    v_fmac_f32 v87, s54, v115
    v_fmac_f32 v88, s54, v116
    v_fmac_f32 v89, s54, v117
    v_cvt_pk_bf16_f32 v80, v86, v87
    v_cvt_pk_bf16_f32 v81, v88, v89
    buffer_store_dwordx2 v[80:81], v70, s[28:31], s58 offen offset:2048 sc1
    v_mov_b32_dpp v120, v74 row_newbcast:2 row_mask:0xf bank_mask:0xf
    v_mov_b32_dpp v121, v75 row_newbcast:2 row_mask:0xf bank_mask:0xf
    v_lshlrev_b32 v86, 16, v82
    v_and_b32 v87, 0xffff0000, v82
    v_lshlrev_b32 v88, 16, v83
    v_and_b32 v89, 0xffff0000, v83
    v_fma_f32 v86, v86, v120, v121
    v_fma_f32 v87, v87, v120, v121
    v_fma_f32 v88, v88, v120, v121
    v_fma_f32 v89, v89, v120, v121
    s_barrier
    ds_read_b128 v[102:105], v69 offset:0
    ds_read_b128 v[106:109], v69 offset:4096
    ds_read_b128 v[110:113], v69 offset:8192
    ds_read_b128 v[114:117], v69 offset:12288
    s_waitcnt lgkmcnt(3)
    v_fmac_f32 v86, s54, v102
    v_fmac_f32 v87, s54, v103
    v_fmac_f32 v88, s54, v104
    v_fmac_f32 v89, s54, v105
    s_waitcnt lgkmcnt(2)
    v_fmac_f32 v86, s54, v106
    v_fmac_f32 v87, s54, v107
    v_fmac_f32 v88, s54, v108
    v_fmac_f32 v89, s54, v109
    s_waitcnt lgkmcnt(1)
    v_fmac_f32 v86, s54, v110
    v_fmac_f32 v87, s54, v111
    v_fmac_f32 v88, s54, v112
    v_fmac_f32 v89, s54, v113
    s_waitcnt lgkmcnt(0)
    v_fmac_f32 v86, s54, v114
    v_fmac_f32 v87, s54, v115
    v_fmac_f32 v88, s54, v116
    v_fmac_f32 v89, s54, v117
    v_cvt_pk_bf16_f32 v82, v86, v87
    v_cvt_pk_bf16_f32 v83, v88, v89
    buffer_store_dwordx2 v[82:83], v70, s[28:31], s59 offen offset:0 sc1
    v_mov_b32_dpp v120, v74 row_newbcast:3 row_mask:0xf bank_mask:0xf
    v_mov_b32_dpp v121, v75 row_newbcast:3 row_mask:0xf bank_mask:0xf
    v_lshlrev_b32 v86, 16, v84
    v_and_b32 v87, 0xffff0000, v84
    v_lshlrev_b32 v88, 16, v85
    v_and_b32 v89, 0xffff0000, v85
    v_fma_f32 v86, v86, v120, v121
    v_fma_f32 v87, v87, v120, v121
    v_fma_f32 v88, v88, v120, v121
    v_fma_f32 v89, v89, v120, v121
    s_setprio 3
    s_barrier
    ds_read_b128 v[102:105], v69 offset:16384
    ds_read_b128 v[106:109], v69 offset:20480
    ds_read_b128 v[110:113], v69 offset:24576
    ds_read_b128 v[114:117], v69 offset:28672
    s_waitcnt lgkmcnt(3)
    v_pk_fma_f32 v[86:87], v[102:103], v[118:119], v[86:87] op_sel_hi:[1,0,1]
    v_pk_fma_f32 v[88:89], v[104:105], v[118:119], v[88:89] op_sel_hi:[1,0,1]
    s_waitcnt lgkmcnt(2)
    v_pk_fma_f32 v[86:87], v[106:107], v[118:119], v[86:87] op_sel_hi:[1,0,1]
    v_pk_fma_f32 v[88:89], v[108:109], v[118:119], v[88:89] op_sel_hi:[1,0,1]
    s_waitcnt lgkmcnt(1)
    v_pk_fma_f32 v[86:87], v[110:111], v[118:119], v[86:87] op_sel_hi:[1,0,1]
    v_pk_fma_f32 v[88:89], v[112:113], v[118:119], v[88:89] op_sel_hi:[1,0,1]
    s_waitcnt lgkmcnt(0)
    v_pk_fma_f32 v[86:87], v[114:115], v[118:119], v[86:87] op_sel_hi:[1,0,1]
    v_pk_fma_f32 v[88:89], v[116:117], v[118:119], v[88:89] op_sel_hi:[1,0,1]
    v_cvt_pk_bf16_f32 v84, v86, v87
    v_cvt_pk_bf16_f32 v85, v88, v89
    buffer_store_dwordx2 v[84:85], v70, s[28:31], s59 offen offset:2048 sc1
    s_endpgm
L_z1_retry_2:
    s_mov_b32 s48, 0
L_z1_loop_22:
    buffer_load_dword v120, v7, s[32:35], s60 offen offset:0 sc1
    buffer_load_dword v121, v7, s[32:35], s60 offen offset:128 sc1
    buffer_load_dword v122, v7, s[32:35], s60 offen offset:256 sc1
    buffer_load_dword v123, v7, s[32:35], s60 offen offset:384 sc1
    buffer_load_dword v124, v7, s[32:35], s60 offen offset:1024 sc1
    buffer_load_dword v125, v7, s[32:35], s60 offen offset:1152 sc1
    buffer_load_dword v126, v7, s[32:35], s60 offen offset:1280 sc1
    buffer_load_dword v127, v7, s[32:35], s60 offen offset:1408 sc1
    buffer_load_dword v128, v7, s[32:35], s60 offen offset:2048 sc1
    buffer_load_dword v129, v7, s[32:35], s60 offen offset:2176 sc1
    buffer_load_dword v130, v7, s[32:35], s60 offen offset:2304 sc1
    buffer_load_dword v131, v7, s[32:35], s60 offen offset:2432 sc1
    buffer_load_dword v132, v7, s[32:35], s60 offen offset:3072 sc1
    buffer_load_dword v133, v7, s[32:35], s60 offen offset:3200 sc1
    buffer_load_dword v134, v7, s[32:35], s60 offen offset:3328 sc1
    buffer_load_dword v135, v7, s[32:35], s60 offen offset:3456 sc1
    s_waitcnt vmcnt(0)
    v_xor_b32 v120, v61, v120
    v_xor_b32 v121, v61, v121
    v_xor_b32 v122, v61, v122
    v_xor_b32 v123, v61, v123
    v_or_b32 v1, v120, v121
    v_or3_b32 v1, v1, v122, v123
    v_mfma_f32_16x16x32_f16 v[136:139], v[88:91], v[120:123], 0
    v_xor_b32 v124, v61, v124
    v_xor_b32 v125, v61, v125
    v_xor_b32 v126, v61, v126
    v_xor_b32 v127, v61, v127
    v_or3_b32 v1, v1, v124, v125
    v_or3_b32 v1, v1, v126, v127
    v_mfma_f32_16x16x32_f16 v[140:143], v[92:95], v[124:127], 0
    v_xor_b32 v128, v61, v128
    v_xor_b32 v129, v61, v129
    v_xor_b32 v130, v61, v130
    v_xor_b32 v131, v61, v131
    v_or3_b32 v1, v1, v128, v129
    v_or3_b32 v1, v1, v130, v131
    v_mfma_f32_16x16x32_f16 v[144:147], v[96:99], v[128:131], 0
    v_xor_b32 v132, v61, v132
    v_xor_b32 v133, v61, v133
    v_xor_b32 v134, v61, v134
    v_xor_b32 v135, v61, v135
    v_or3_b32 v1, v1, v132, v133
    v_or3_b32 v1, v1, v134, v135
    v_mfma_f32_16x16x32_f16 v[148:151], v[100:103], v[132:135], 0
    v_and_b32 v1, s46, v1
    v_cmp_ne_u32 vcc, 0, v1
    s_cbranch_vccz L_z1_ok_3
    s_add_u32 s48, s48, 1
    s_cmp_lt_u32 s48, 20000
    s_cbranch_scc1 L_z1_loop_22
    s_branch L_z1_ok_3
L_z2_retry_4:
    s_mov_b32 s48, 0
L_z2_loop_23:
    buffer_load_dword v74, v8, s[32:35], s60 offen offset:0 sc1
    buffer_load_dword v75, v8, s[32:35], s60 offen offset:128 sc1
    buffer_load_dword v76, v8, s[32:35], s60 offen offset:256 sc1
    buffer_load_dword v77, v8, s[32:35], s60 offen offset:384 sc1
    buffer_load_dword v78, v8, s[32:35], s60 offen offset:2048 sc1
    buffer_load_dword v79, v8, s[32:35], s60 offen offset:2176 sc1
    buffer_load_dword v80, v8, s[32:35], s60 offen offset:2304 sc1
    buffer_load_dword v81, v8, s[32:35], s60 offen offset:2432 sc1
    buffer_load_dword v82, v8, s[32:35], s61 offen offset:0 sc1
    buffer_load_dword v83, v8, s[32:35], s61 offen offset:128 sc1
    buffer_load_dword v84, v8, s[32:35], s61 offen offset:256 sc1
    buffer_load_dword v85, v8, s[32:35], s61 offen offset:384 sc1
    buffer_load_dword v86, v8, s[32:35], s61 offen offset:2048 sc1
    buffer_load_dword v87, v8, s[32:35], s61 offen offset:2176 sc1
    buffer_load_dword v88, v8, s[32:35], s61 offen offset:2304 sc1
    buffer_load_dword v89, v8, s[32:35], s61 offen offset:2432 sc1
    s_waitcnt vmcnt(0)
    v_xor_b32 v74, v26, v74
    v_xor_b32 v75, v26, v75
    v_xor_b32 v76, v26, v76
    v_xor_b32 v77, v26, v77
    v_or_b32 v1, v74, v75
    v_or3_b32 v1, v1, v76, v77
    v_mfma_f32_16x16x32_bf16 v[106:109], v[52:55], v[74:77], 0
    v_xor_b32 v78, v26, v78
    v_xor_b32 v79, v26, v79
    v_xor_b32 v80, v26, v80
    v_xor_b32 v81, v26, v81
    v_or3_b32 v1, v1, v78, v79
    v_or3_b32 v1, v1, v80, v81
    v_mfma_f32_16x16x32_bf16 v[110:113], v[52:55], v[78:81], 0
    v_xor_b32 v82, v26, v82
    v_xor_b32 v83, v26, v83
    v_xor_b32 v84, v26, v84
    v_xor_b32 v85, v26, v85
    v_or3_b32 v1, v1, v82, v83
    v_or3_b32 v1, v1, v84, v85
    v_mfma_f32_16x16x32_bf16 v[114:117], v[52:55], v[82:85], 0
    v_xor_b32 v86, v26, v86
    v_xor_b32 v87, v26, v87
    v_xor_b32 v88, v26, v88
    v_xor_b32 v89, v26, v89
    v_or3_b32 v1, v1, v86, v87
    v_or3_b32 v1, v1, v88, v89
    v_mfma_f32_16x16x32_bf16 v[118:121], v[52:55], v[86:89], 0
    v_and_b32 v1, s46, v1
    v_cmp_ne_u32 vcc, 0, v1
    s_cbranch_vccz L_z2_ok_5
    s_add_u32 s48, s48, 1
    s_cmp_lt_u32 s48, 20000
    s_cbranch_scc1 L_z2_loop_23
    s_branch L_z2_ok_5
L_hn_retry_6:
    s_mov_b32 s48, 0
L_hn_loop_24:
    buffer_load_dword v8, v15, s[32:35], 0 offen sc1
    s_waitcnt vmcnt(0)
    v_cmp_ne_u32 vcc, s47, v8
    s_cbranch_vccz L_hn_ok_7
    s_add_u32 s48, s48, 1
    s_cmp_lt_u32 s48, 20000
    s_cbranch_scc1 L_hn_loop_24
    s_branch L_hn_ok_7
L_redo_10:
    s_waitcnt vmcnt(0)
    s_mov_b32 s48, 0
L_redo_loop_25:
    s_add_u32 s51, s68, 0
    buffer_load_dwordx4 v[36:39], v0, s[32:35], s51 offen sc1
    s_add_u32 s51, s69, 0
    buffer_load_dwordx4 v[40:43], v0, s[32:35], s51 offen sc1
    s_add_u32 s51, s70, 0
    buffer_load_dwordx4 v[44:47], v0, s[32:35], s51 offen sc1
    s_add_u32 s48, s48, 1
    s_waitcnt vmcnt(0)
    v_max3_u32 v1, v36, v40, v44
    v_cmp_eq_u32 vcc, -1, v1
    s_cbranch_vccz L_redo_got_26
    s_cmp_lt_u32 s48, 20000
    s_cbranch_scc1 L_redo_loop_25
L_redo_got_26:
    v_mfma_f32_16x16x32_bf16 v[48:51], v[80:83], v[36:39], 0
    v_mfma_f32_16x16x32_bf16 v[52:55], v[84:87], v[36:39], 0
    v_mfma_f32_16x16x32_bf16 v[56:59], v[88:91], v[36:39], 0
    v_mfma_f32_16x16x32_bf16 v[60:63], v[92:95], v[36:39], 0
    v_mfma_f32_16x16x32_bf16 v[48:51], v[96:99], v[40:43], v[48:51]
    v_mfma_f32_16x16x32_bf16 v[52:55], v[100:103], v[40:43], v[52:55]
    v_mfma_f32_16x16x32_bf16 v[56:59], v[104:107], v[40:43], v[56:59]
    v_mfma_f32_16x16x32_bf16 v[60:63], v[108:111], v[40:43], v[60:63]
    v_mfma_f32_16x16x32_bf16 v[48:51], v[112:115], v[44:47], v[48:51]
    v_mfma_f32_16x16x32_bf16 v[52:55], v[116:119], v[44:47], v[52:55]
    v_mfma_f32_16x16x32_bf16 v[56:59], v[120:123], v[44:47], v[56:59]
    v_mfma_f32_16x16x32_bf16 v[60:63], v[124:127], v[44:47], v[60:63]
    s_mov_b32 s48, 0
L_redo_loop_27:
    s_add_u32 s51, s71, 0
    buffer_load_dwordx4 v[36:39], v0, s[32:35], s51 offen sc1
    s_add_u32 s51, s72, 0
    buffer_load_dwordx4 v[40:43], v0, s[32:35], s51 offen sc1
    s_add_u32 s51, s73, 0
    buffer_load_dwordx4 v[44:47], v0, s[32:35], s51 offen sc1
    s_add_u32 s48, s48, 1
    s_waitcnt vmcnt(0)
    v_max3_u32 v1, v36, v40, v44
    v_cmp_eq_u32 vcc, -1, v1
    s_cbranch_vccz L_redo_got_28
    s_cmp_lt_u32 s48, 20000
    s_cbranch_scc1 L_redo_loop_27
L_redo_got_28:
    v_mfma_f32_16x16x32_bf16 v[48:51], v[128:131], v[36:39], v[48:51]
    v_mfma_f32_16x16x32_bf16 v[52:55], v[132:135], v[36:39], v[52:55]
    v_mfma_f32_16x16x32_bf16 v[56:59], v[136:139], v[36:39], v[56:59]
    v_mfma_f32_16x16x32_bf16 v[60:63], v[140:143], v[36:39], v[60:63]
    v_mfma_f32_16x16x32_bf16 v[48:51], v[144:147], v[40:43], v[48:51]
    v_mfma_f32_16x16x32_bf16 v[52:55], v[148:151], v[40:43], v[52:55]
    v_mfma_f32_16x16x32_bf16 v[56:59], v[152:155], v[40:43], v[56:59]
    v_mfma_f32_16x16x32_bf16 v[60:63], v[156:159], v[40:43], v[60:63]
    v_mfma_f32_16x16x32_bf16 v[48:51], v[160:163], v[44:47], v[48:51]
    v_mfma_f32_16x16x32_bf16 v[52:55], v[164:167], v[44:47], v[52:55]
    v_mfma_f32_16x16x32_bf16 v[56:59], v[168:171], v[44:47], v[56:59]
    v_mfma_f32_16x16x32_bf16 v[60:63], v[172:175], v[44:47], v[60:63]
    s_mov_b32 s48, 0
L_redo_loop_29:
    s_add_u32 s51, s74, 0
    buffer_load_dwordx4 v[36:39], v0, s[32:35], s51 offen sc1
    s_add_u32 s51, s75, 0
    buffer_load_dwordx4 v[40:43], v0, s[32:35], s51 offen sc1
    s_add_u32 s51, s76, 0
    buffer_load_dwordx4 v[44:47], v0, s[32:35], s51 offen sc1
    s_add_u32 s48, s48, 1
    s_waitcnt vmcnt(0)
    v_max3_u32 v1, v36, v40, v44
    v_cmp_eq_u32 vcc, -1, v1
    s_cbranch_vccz L_redo_got_30
    s_cmp_lt_u32 s48, 20000
    s_cbranch_scc1 L_redo_loop_29
L_redo_got_30:
    v_mfma_f32_16x16x32_bf16 v[48:51], v[176:179], v[36:39], v[48:51]
    v_mfma_f32_16x16x32_bf16 v[52:55], v[180:183], v[36:39], v[52:55]
    v_mfma_f32_16x16x32_bf16 v[56:59], v[184:187], v[36:39], v[56:59]
    v_mfma_f32_16x16x32_bf16 v[60:63], v[188:191], v[36:39], v[60:63]
    v_mfma_f32_16x16x32_bf16 v[48:51], v[192:195], v[40:43], v[48:51]
    v_mfma_f32_16x16x32_bf16 v[52:55], v[196:199], v[40:43], v[52:55]
    v_mfma_f32_16x16x32_bf16 v[56:59], v[200:203], v[40:43], v[56:59]
    v_mfma_f32_16x16x32_bf16 v[60:63], v[204:207], v[40:43], v[60:63]
    v_mfma_f32_16x16x32_bf16 v[48:51], v[208:211], v[44:47], v[48:51]
    v_mfma_f32_16x16x32_bf16 v[52:55], v[212:215], v[44:47], v[52:55]
    v_mfma_f32_16x16x32_bf16 v[56:59], v[216:219], v[44:47], v[56:59]
    v_mfma_f32_16x16x32_bf16 v[60:63], v[220:223], v[44:47], v[60:63]
    s_mov_b32 s48, 0
L_redo_loop_31:
    s_add_u32 s51, s77, 0
    buffer_load_dwordx4 v[36:39], v0, s[32:35], s51 offen sc1
    s_add_u32 s51, s78, 0
    buffer_load_dwordx4 v[40:43], v0, s[32:35], s51 offen sc1
    s_add_u32 s48, s48, 1
    s_waitcnt vmcnt(0)
    v_max3_u32 v1, v36, v40, v40
    v_cmp_eq_u32 vcc, -1, v1
    s_cbranch_vccz L_redo_got_32
    s_cmp_lt_u32 s48, 20000
    s_cbranch_scc1 L_redo_loop_31
L_redo_got_32:
    v_mfma_f32_16x16x32_bf16 v[48:51], v[224:227], v[36:39], v[48:51]
    v_mfma_f32_16x16x32_bf16 v[52:55], v[228:231], v[36:39], v[52:55]
    v_mfma_f32_16x16x32_bf16 v[56:59], v[232:235], v[36:39], v[56:59]
    v_mfma_f32_16x16x32_bf16 v[60:63], v[236:239], v[36:39], v[60:63]
    v_mfma_f32_16x16x32_bf16 v[48:51], v[240:243], v[40:43], v[48:51]
    v_mfma_f32_16x16x32_bf16 v[52:55], v[244:247], v[40:43], v[52:55]
    v_mfma_f32_16x16x32_bf16 v[56:59], v[248:251], v[40:43], v[56:59]
    v_mfma_f32_16x16x32_bf16 v[60:63], v[252:255], v[40:43], v[60:63]
    s_add_u32 s51, s76, 45056
    buffer_load_dwordx4 v[36:39], v0, s[32:35], s51 offen sc1
    s_add_u32 s51, s77, 45056
    buffer_load_dwordx4 v[40:43], v0, s[32:35], s51 offen sc1
    s_add_u32 s51, s78, 45056
    buffer_load_dwordx4 v[44:47], v0, s[32:35], s51 offen sc1
    s_waitcnt vmcnt(0)
    s_nop 7
    s_branch L_redone_11
L_redo_12:
    s_waitcnt vmcnt(0)
    s_mov_b32 s48, 0
L_redo_loop_33:
    s_add_u32 s51, s68, 45056
    buffer_load_dwordx4 v[36:39], v0, s[32:35], s51 offen sc1
    s_add_u32 s51, s69, 45056
    buffer_load_dwordx4 v[40:43], v0, s[32:35], s51 offen sc1
    s_add_u32 s51, s70, 45056
    buffer_load_dwordx4 v[44:47], v0, s[32:35], s51 offen sc1
    s_add_u32 s48, s48, 1
    s_waitcnt vmcnt(0)
    v_max3_u32 v1, v36, v40, v44
    v_cmp_eq_u32 vcc, -1, v1
    s_cbranch_vccz L_redo_got_34
    s_cmp_lt_u32 s48, 20000
    s_cbranch_scc1 L_redo_loop_33
L_redo_got_34:
    v_mfma_f32_16x16x32_bf16 v[64:67], v[80:83], v[36:39], 0
    v_mfma_f32_16x16x32_bf16 v[68:71], v[84:87], v[36:39], 0
    v_mfma_f32_16x16x32_bf16 v[72:75], v[88:91], v[36:39], 0
    v_mfma_f32_16x16x32_bf16 v[76:79], v[92:95], v[36:39], 0
    v_mfma_f32_16x16x32_bf16 v[64:67], v[96:99], v[40:43], v[64:67]
    v_mfma_f32_16x16x32_bf16 v[68:71], v[100:103], v[40:43], v[68:71]
    v_mfma_f32_16x16x32_bf16 v[72:75], v[104:107], v[40:43], v[72:75]
    v_mfma_f32_16x16x32_bf16 v[76:79], v[108:111], v[40:43], v[76:79]
    v_mfma_f32_16x16x32_bf16 v[64:67], v[112:115], v[44:47], v[64:67]
    v_mfma_f32_16x16x32_bf16 v[68:71], v[116:119], v[44:47], v[68:71]
    v_mfma_f32_16x16x32_bf16 v[72:75], v[120:123], v[44:47], v[72:75]
    v_mfma_f32_16x16x32_bf16 v[76:79], v[124:127], v[44:47], v[76:79]
    s_mov_b32 s48, 0
L_redo_loop_35:
    s_add_u32 s51, s71, 45056
    buffer_load_dwordx4 v[36:39], v0, s[32:35], s51 offen sc1
    s_add_u32 s51, s72, 45056
    buffer_load_dwordx4 v[40:43], v0, s[32:35], s51 offen sc1
    s_add_u32 s51, s73, 45056
    buffer_load_dwordx4 v[44:47], v0, s[32:35], s51 offen sc1
    s_add_u32 s48, s48, 1
    s_waitcnt vmcnt(0)
    v_max3_u32 v1, v36, v40, v44
    v_cmp_eq_u32 vcc, -1, v1
    s_cbranch_vccz L_redo_got_36
    s_cmp_lt_u32 s48, 20000
    s_cbranch_scc1 L_redo_loop_35
L_redo_got_36:
    v_mfma_f32_16x16x32_bf16 v[64:67], v[128:131], v[36:39], v[64:67]
    v_mfma_f32_16x16x32_bf16 v[68:71], v[132:135], v[36:39], v[68:71]
    v_mfma_f32_16x16x32_bf16 v[72:75], v[136:139], v[36:39], v[72:75]
    v_mfma_f32_16x16x32_bf16 v[76:79], v[140:143], v[36:39], v[76:79]
    v_mfma_f32_16x16x32_bf16 v[64:67], v[144:147], v[40:43], v[64:67]
    v_mfma_f32_16x16x32_bf16 v[68:71], v[148:151], v[40:43], v[68:71]
    v_mfma_f32_16x16x32_bf16 v[72:75], v[152:155], v[40:43], v[72:75]
    v_mfma_f32_16x16x32_bf16 v[76:79], v[156:159], v[40:43], v[76:79]
    v_mfma_f32_16x16x32_bf16 v[64:67], v[160:163], v[44:47], v[64:67]
    v_mfma_f32_16x16x32_bf16 v[68:71], v[164:167], v[44:47], v[68:71]
    v_mfma_f32_16x16x32_bf16 v[72:75], v[168:171], v[44:47], v[72:75]
    v_mfma_f32_16x16x32_bf16 v[76:79], v[172:175], v[44:47], v[76:79]
    s_mov_b32 s48, 0
L_redo_loop_37:
    s_add_u32 s51, s74, 45056
    buffer_load_dwordx4 v[36:39], v0, s[32:35], s51 offen sc1
    s_add_u32 s51, s75, 45056
    buffer_load_dwordx4 v[40:43], v0, s[32:35], s51 offen sc1
    s_add_u32 s51, s76, 45056
    buffer_load_dwordx4 v[44:47], v0, s[32:35], s51 offen sc1
    s_add_u32 s48, s48, 1
    s_waitcnt vmcnt(0)
    v_max3_u32 v1, v36, v40, v44
    v_cmp_eq_u32 vcc, -1, v1
    s_cbranch_vccz L_redo_got_38
    s_cmp_lt_u32 s48, 20000
    s_cbranch_scc1 L_redo_loop_37
L_redo_got_38:
    v_mfma_f32_16x16x32_bf16 v[64:67], v[176:179], v[36:39], v[64:67]
    v_mfma_f32_16x16x32_bf16 v[68:71], v[180:183], v[36:39], v[68:71]
    v_mfma_f32_16x16x32_bf16 v[72:75], v[184:187], v[36:39], v[72:75]
    v_mfma_f32_16x16x32_bf16 v[76:79], v[188:191], v[36:39], v[76:79]
    v_mfma_f32_16x16x32_bf16 v[64:67], v[192:195], v[40:43], v[64:67]
    v_mfma_f32_16x16x32_bf16 v[68:71], v[196:199], v[40:43], v[68:71]
    v_mfma_f32_16x16x32_bf16 v[72:75], v[200:203], v[40:43], v[72:75]
    v_mfma_f32_16x16x32_bf16 v[76:79], v[204:207], v[40:43], v[76:79]
    v_mfma_f32_16x16x32_bf16 v[64:67], v[208:211], v[44:47], v[64:67]
    v_mfma_f32_16x16x32_bf16 v[68:71], v[212:215], v[44:47], v[68:71]
    v_mfma_f32_16x16x32_bf16 v[72:75], v[216:219], v[44:47], v[72:75]
    v_mfma_f32_16x16x32_bf16 v[76:79], v[220:223], v[44:47], v[76:79]
    s_mov_b32 s48, 0
L_redo_loop_39:
    s_add_u32 s51, s77, 45056
    buffer_load_dwordx4 v[36:39], v0, s[32:35], s51 offen sc1
    s_add_u32 s51, s78, 45056
    buffer_load_dwordx4 v[40:43], v0, s[32:35], s51 offen sc1
    s_add_u32 s48, s48, 1
    s_waitcnt vmcnt(0)
    v_max3_u32 v1, v36, v40, v40
    v_cmp_eq_u32 vcc, -1, v1
    s_cbranch_vccz L_redo_got_40
    s_cmp_lt_u32 s48, 20000
    s_cbranch_scc1 L_redo_loop_39
L_redo_got_40:
    v_mfma_f32_16x16x32_bf16 v[64:67], v[224:227], v[36:39], v[64:67]
    v_mfma_f32_16x16x32_bf16 v[68:71], v[228:231], v[36:39], v[68:71]
    v_mfma_f32_16x16x32_bf16 v[72:75], v[232:235], v[36:39], v[72:75]
    v_mfma_f32_16x16x32_bf16 v[76:79], v[236:239], v[36:39], v[76:79]
    v_mfma_f32_16x16x32_bf16 v[64:67], v[240:243], v[40:43], v[64:67]
    v_mfma_f32_16x16x32_bf16 v[68:71], v[244:247], v[40:43], v[68:71]
    v_mfma_f32_16x16x32_bf16 v[72:75], v[248:251], v[40:43], v[72:75]
    v_mfma_f32_16x16x32_bf16 v[76:79], v[252:255], v[40:43], v[76:79]
    s_add_u32 s51, s76, 90112
    buffer_load_dwordx4 v[36:39], v0, s[32:35], s51 offen sc1
    s_add_u32 s51, s77, 90112
    buffer_load_dwordx4 v[40:43], v0, s[32:35], s51 offen sc1
    s_add_u32 s51, s78, 90112
    buffer_load_dwordx4 v[44:47], v0, s[32:35], s51 offen sc1
    s_waitcnt vmcnt(0)
    s_nop 7
    s_branch L_redone_13
L_redo_14:
    s_waitcnt vmcnt(0)
    s_mov_b32 s48, 0
L_redo_loop_41:
    s_add_u32 s51, s68, 90112
    buffer_load_dwordx4 v[36:39], v0, s[32:35], s51 offen sc1
    s_add_u32 s51, s69, 90112
    buffer_load_dwordx4 v[40:43], v0, s[32:35], s51 offen sc1
    s_add_u32 s51, s70, 90112
    buffer_load_dwordx4 v[44:47], v0, s[32:35], s51 offen sc1
    s_add_u32 s48, s48, 1
    s_waitcnt vmcnt(0)
    v_max3_u32 v1, v36, v40, v44
    v_cmp_eq_u32 vcc, -1, v1
    s_cbranch_vccz L_redo_got_42
    s_cmp_lt_u32 s48, 20000
    s_cbranch_scc1 L_redo_loop_41
L_redo_got_42:
    v_mfma_f32_16x16x32_bf16 v[48:51], v[80:83], v[36:39], 0
    v_mfma_f32_16x16x32_bf16 v[52:55], v[84:87], v[36:39], 0
    v_mfma_f32_16x16x32_bf16 v[56:59], v[88:91], v[36:39], 0
    v_mfma_f32_16x16x32_bf16 v[60:63], v[92:95], v[36:39], 0
    v_mfma_f32_16x16x32_bf16 v[48:51], v[96:99], v[40:43], v[48:51]
    v_mfma_f32_16x16x32_bf16 v[52:55], v[100:103], v[40:43], v[52:55]
    v_mfma_f32_16x16x32_bf16 v[56:59], v[104:107], v[40:43], v[56:59]
    v_mfma_f32_16x16x32_bf16 v[60:63], v[108:111], v[40:43], v[60:63]
    v_mfma_f32_16x16x32_bf16 v[48:51], v[112:115], v[44:47], v[48:51]
    v_mfma_f32_16x16x32_bf16 v[52:55], v[116:119], v[44:47], v[52:55]
    v_mfma_f32_16x16x32_bf16 v[56:59], v[120:123], v[44:47], v[56:59]
    v_mfma_f32_16x16x32_bf16 v[60:63], v[124:127], v[44:47], v[60:63]
    s_mov_b32 s48, 0
L_redo_loop_43:
    s_add_u32 s51, s71, 90112
    buffer_load_dwordx4 v[36:39], v0, s[32:35], s51 offen sc1
    s_add_u32 s51, s72, 90112
    buffer_load_dwordx4 v[40:43], v0, s[32:35], s51 offen sc1
    s_add_u32 s51, s73, 90112
    buffer_load_dwordx4 v[44:47], v0, s[32:35], s51 offen sc1
    s_add_u32 s48, s48, 1
    s_waitcnt vmcnt(0)
    v_max3_u32 v1, v36, v40, v44
    v_cmp_eq_u32 vcc, -1, v1
    s_cbranch_vccz L_redo_got_44
    s_cmp_lt_u32 s48, 20000
    s_cbranch_scc1 L_redo_loop_43
L_redo_got_44:
    v_mfma_f32_16x16x32_bf16 v[48:51], v[128:131], v[36:39], v[48:51]
    v_mfma_f32_16x16x32_bf16 v[52:55], v[132:135], v[36:39], v[52:55]
    v_mfma_f32_16x16x32_bf16 v[56:59], v[136:139], v[36:39], v[56:59]
    v_mfma_f32_16x16x32_bf16 v[60:63], v[140:143], v[36:39], v[60:63]
    v_mfma_f32_16x16x32_bf16 v[48:51], v[144:147], v[40:43], v[48:51]
    v_mfma_f32_16x16x32_bf16 v[52:55], v[148:151], v[40:43], v[52:55]
    v_mfma_f32_16x16x32_bf16 v[56:59], v[152:155], v[40:43], v[56:59]
    v_mfma_f32_16x16x32_bf16 v[60:63], v[156:159], v[40:43], v[60:63]
    v_mfma_f32_16x16x32_bf16 v[48:51], v[160:163], v[44:47], v[48:51]
    v_mfma_f32_16x16x32_bf16 v[52:55], v[164:167], v[44:47], v[52:55]
    v_mfma_f32_16x16x32_bf16 v[56:59], v[168:171], v[44:47], v[56:59]
    v_mfma_f32_16x16x32_bf16 v[60:63], v[172:175], v[44:47], v[60:63]
    s_mov_b32 s48, 0
L_redo_loop_45:
    s_add_u32 s51, s74, 90112
    buffer_load_dwordx4 v[36:39], v0, s[32:35], s51 offen sc1
    s_add_u32 s51, s75, 90112
    buffer_load_dwordx4 v[40:43], v0, s[32:35], s51 offen sc1
    s_add_u32 s51, s76, 90112
    buffer_load_dwordx4 v[44:47], v0, s[32:35], s51 offen sc1
    s_add_u32 s48, s48, 1
    s_waitcnt vmcnt(0)
    v_max3_u32 v1, v36, v40, v44
    v_cmp_eq_u32 vcc, -1, v1
    s_cbranch_vccz L_redo_got_46
    s_cmp_lt_u32 s48, 20000
    s_cbranch_scc1 L_redo_loop_45
L_redo_got_46:
    v_mfma_f32_16x16x32_bf16 v[48:51], v[176:179], v[36:39], v[48:51]
    v_mfma_f32_16x16x32_bf16 v[52:55], v[180:183], v[36:39], v[52:55]
    v_mfma_f32_16x16x32_bf16 v[56:59], v[184:187], v[36:39], v[56:59]
    v_mfma_f32_16x16x32_bf16 v[60:63], v[188:191], v[36:39], v[60:63]
    v_mfma_f32_16x16x32_bf16 v[48:51], v[192:195], v[40:43], v[48:51]
    v_mfma_f32_16x16x32_bf16 v[52:55], v[196:199], v[40:43], v[52:55]
    v_mfma_f32_16x16x32_bf16 v[56:59], v[200:203], v[40:43], v[56:59]
    v_mfma_f32_16x16x32_bf16 v[60:63], v[204:207], v[40:43], v[60:63]
    v_mfma_f32_16x16x32_bf16 v[48:51], v[208:211], v[44:47], v[48:51]
    v_mfma_f32_16x16x32_bf16 v[52:55], v[212:215], v[44:47], v[52:55]
    v_mfma_f32_16x16x32_bf16 v[56:59], v[216:219], v[44:47], v[56:59]
    v_mfma_f32_16x16x32_bf16 v[60:63], v[220:223], v[44:47], v[60:63]
    s_mov_b32 s48, 0
L_redo_loop_47:
    s_add_u32 s51, s77, 90112
    buffer_load_dwordx4 v[36:39], v0, s[32:35], s51 offen sc1
    s_add_u32 s51, s78, 90112
    buffer_load_dwordx4 v[40:43], v0, s[32:35], s51 offen sc1
    s_add_u32 s48, s48, 1
    s_waitcnt vmcnt(0)
    v_max3_u32 v1, v36, v40, v40
    v_cmp_eq_u32 vcc, -1, v1
    s_cbranch_vccz L_redo_got_48
    s_cmp_lt_u32 s48, 20000
    s_cbranch_scc1 L_redo_loop_47
L_redo_got_48:
    v_mfma_f32_16x16x32_bf16 v[48:51], v[224:227], v[36:39], v[48:51]
    v_mfma_f32_16x16x32_bf16 v[52:55], v[228:231], v[36:39], v[52:55]
    v_mfma_f32_16x16x32_bf16 v[56:59], v[232:235], v[36:39], v[56:59]
    v_mfma_f32_16x16x32_bf16 v[60:63], v[236:239], v[36:39], v[60:63]
    v_mfma_f32_16x16x32_bf16 v[48:51], v[240:243], v[40:43], v[48:51]
    v_mfma_f32_16x16x32_bf16 v[52:55], v[244:247], v[40:43], v[52:55]
    v_mfma_f32_16x16x32_bf16 v[56:59], v[248:251], v[40:43], v[56:59]
    v_mfma_f32_16x16x32_bf16 v[60:63], v[252:255], v[40:43], v[60:63]
    s_add_u32 s51, s76, 135168
    buffer_load_dwordx4 v[36:39], v0, s[32:35], s51 offen sc1
    s_add_u32 s51, s77, 135168
    buffer_load_dwordx4 v[40:43], v0, s[32:35], s51 offen sc1
    s_add_u32 s51, s78, 135168
    buffer_load_dwordx4 v[44:47], v0, s[32:35], s51 offen sc1
    s_waitcnt vmcnt(0)
    s_nop 7
    s_branch L_redone_15
L_redo_18:
    s_waitcnt vmcnt(0)
    s_mov_b32 s48, 0
L_redo_loop_49:
    s_add_u32 s51, s68, 135168
    buffer_load_dwordx4 v[36:39], v0, s[32:35], s51 offen sc1
    s_add_u32 s51, s69, 135168
    buffer_load_dwordx4 v[40:43], v0, s[32:35], s51 offen sc1
    s_add_u32 s51, s70, 135168
    buffer_load_dwordx4 v[44:47], v0, s[32:35], s51 offen sc1
    s_add_u32 s48, s48, 1
    s_waitcnt vmcnt(0)
    v_max3_u32 v1, v36, v40, v44
    v_cmp_eq_u32 vcc, -1, v1
    s_cbranch_vccz L_redo_got_50
    s_cmp_lt_u32 s48, 20000
    s_cbranch_scc1 L_redo_loop_49
L_redo_got_50:
    v_mfma_f32_16x16x32_bf16 v[64:67], v[80:83], v[36:39], 0
    v_mfma_f32_16x16x32_bf16 v[68:71], v[84:87], v[36:39], 0
    v_mfma_f32_16x16x32_bf16 v[72:75], v[88:91], v[36:39], 0
    v_mfma_f32_16x16x32_bf16 v[76:79], v[92:95], v[36:39], 0
    v_mfma_f32_16x16x32_bf16 v[64:67], v[96:99], v[40:43], v[64:67]
    v_mfma_f32_16x16x32_bf16 v[68:71], v[100:103], v[40:43], v[68:71]
    v_mfma_f32_16x16x32_bf16 v[72:75], v[104:107], v[40:43], v[72:75]
    v_mfma_f32_16x16x32_bf16 v[76:79], v[108:111], v[40:43], v[76:79]
    v_mfma_f32_16x16x32_bf16 v[64:67], v[112:115], v[44:47], v[64:67]
    v_mfma_f32_16x16x32_bf16 v[68:71], v[116:119], v[44:47], v[68:71]
    v_mfma_f32_16x16x32_bf16 v[72:75], v[120:123], v[44:47], v[72:75]
    v_mfma_f32_16x16x32_bf16 v[76:79], v[124:127], v[44:47], v[76:79]
    s_mov_b32 s48, 0
L_redo_loop_51:
    s_add_u32 s51, s71, 135168
    buffer_load_dwordx4 v[36:39], v0, s[32:35], s51 offen sc1
    s_add_u32 s51, s72, 135168
    buffer_load_dwordx4 v[40:43], v0, s[32:35], s51 offen sc1
    s_add_u32 s51, s73, 135168
    buffer_load_dwordx4 v[44:47], v0, s[32:35], s51 offen sc1
    s_add_u32 s48, s48, 1
    s_waitcnt vmcnt(0)
    v_max3_u32 v1, v36, v40, v44
    v_cmp_eq_u32 vcc, -1, v1
    s_cbranch_vccz L_redo_got_52
    s_cmp_lt_u32 s48, 20000
    s_cbranch_scc1 L_redo_loop_51
L_redo_got_52:
    v_mfma_f32_16x16x32_bf16 v[64:67], v[128:131], v[36:39], v[64:67]
    v_mfma_f32_16x16x32_bf16 v[68:71], v[132:135], v[36:39], v[68:71]
    v_mfma_f32_16x16x32_bf16 v[72:75], v[136:139], v[36:39], v[72:75]
    v_mfma_f32_16x16x32_bf16 v[76:79], v[140:143], v[36:39], v[76:79]
    v_mfma_f32_16x16x32_bf16 v[64:67], v[144:147], v[40:43], v[64:67]
    v_mfma_f32_16x16x32_bf16 v[68:71], v[148:151], v[40:43], v[68:71]
    v_mfma_f32_16x16x32_bf16 v[72:75], v[152:155], v[40:43], v[72:75]
    v_mfma_f32_16x16x32_bf16 v[76:79], v[156:159], v[40:43], v[76:79]
    v_mfma_f32_16x16x32_bf16 v[64:67], v[160:163], v[44:47], v[64:67]
    v_mfma_f32_16x16x32_bf16 v[68:71], v[164:167], v[44:47], v[68:71]
    v_mfma_f32_16x16x32_bf16 v[72:75], v[168:171], v[44:47], v[72:75]
    v_mfma_f32_16x16x32_bf16 v[76:79], v[172:175], v[44:47], v[76:79]
    s_mov_b32 s48, 0
L_redo_loop_53:
    s_add_u32 s51, s74, 135168
    buffer_load_dwordx4 v[36:39], v0, s[32:35], s51 offen sc1
    s_add_u32 s51, s75, 135168
    buffer_load_dwordx4 v[40:43], v0, s[32:35], s51 offen sc1
    s_add_u32 s51, s76, 135168
    buffer_load_dwordx4 v[44:47], v0, s[32:35], s51 offen sc1
    s_add_u32 s48, s48, 1
    s_waitcnt vmcnt(0)
    v_max3_u32 v1, v36, v40, v44
    v_cmp_eq_u32 vcc, -1, v1
    s_cbranch_vccz L_redo_got_54
    s_cmp_lt_u32 s48, 20000
    s_cbranch_scc1 L_redo_loop_53
L_redo_got_54:
    v_mfma_f32_16x16x32_bf16 v[64:67], v[176:179], v[36:39], v[64:67]
    v_mfma_f32_16x16x32_bf16 v[68:71], v[180:183], v[36:39], v[68:71]
    v_mfma_f32_16x16x32_bf16 v[72:75], v[184:187], v[36:39], v[72:75]
    v_mfma_f32_16x16x32_bf16 v[76:79], v[188:191], v[36:39], v[76:79]
    v_mfma_f32_16x16x32_bf16 v[64:67], v[192:195], v[40:43], v[64:67]
    v_mfma_f32_16x16x32_bf16 v[68:71], v[196:199], v[40:43], v[68:71]
    v_mfma_f32_16x16x32_bf16 v[72:75], v[200:203], v[40:43], v[72:75]
    v_mfma_f32_16x16x32_bf16 v[76:79], v[204:207], v[40:43], v[76:79]
    v_mfma_f32_16x16x32_bf16 v[64:67], v[208:211], v[44:47], v[64:67]
    v_mfma_f32_16x16x32_bf16 v[68:71], v[212:215], v[44:47], v[68:71]
    v_mfma_f32_16x16x32_bf16 v[72:75], v[216:219], v[44:47], v[72:75]
    v_mfma_f32_16x16x32_bf16 v[76:79], v[220:223], v[44:47], v[76:79]
    s_mov_b32 s48, 0
L_redo_loop_55:
    s_add_u32 s51, s77, 135168
    buffer_load_dwordx4 v[36:39], v0, s[32:35], s51 offen sc1
    s_add_u32 s51, s78, 135168
    buffer_load_dwordx4 v[40:43], v0, s[32:35], s51 offen sc1
    s_add_u32 s48, s48, 1
    s_waitcnt vmcnt(0)
    v_max3_u32 v1, v36, v40, v40
    v_cmp_eq_u32 vcc, -1, v1
    s_cbranch_vccz L_redo_got_56
    s_cmp_lt_u32 s48, 20000
    s_cbranch_scc1 L_redo_loop_55
L_redo_got_56:
    v_mfma_f32_16x16x32_bf16 v[64:67], v[224:227], v[36:39], v[64:67]
    v_mfma_f32_16x16x32_bf16 v[68:71], v[228:231], v[36:39], v[68:71]
    v_mfma_f32_16x16x32_bf16 v[72:75], v[232:235], v[36:39], v[72:75]
    v_mfma_f32_16x16x32_bf16 v[76:79], v[236:239], v[36:39], v[76:79]
    v_mfma_f32_16x16x32_bf16 v[64:67], v[240:243], v[40:43], v[64:67]
    v_mfma_f32_16x16x32_bf16 v[68:71], v[244:247], v[40:43], v[68:71]
    v_mfma_f32_16x16x32_bf16 v[72:75], v[248:251], v[40:43], v[72:75]
    v_mfma_f32_16x16x32_bf16 v[76:79], v[252:255], v[40:43], v[76:79]
    s_nop 7
    s_branch L_redone_19
.p2align 8
.fill 4096, 4, 0xbf810000
.section .rodata,"a"
.p2align 6
.amdhsa_kernel sequential_preLN__spectral_gfnet__dense_activation_silu__prompt_kernel
  .amdhsa_next_free_vgpr 256
  .amdhsa_next_free_sgpr 102
  .amdhsa_accum_offset 256
  .amdhsa_group_segment_fixed_size 0
  .amdhsa_kernarg_size 72
  .amdhsa_user_sgpr_count 2
  .amdhsa_user_sgpr_kernarg_segment_ptr 1
  .amdhsa_system_sgpr_workgroup_id_x 1
  .amdhsa_float_denorm_mode_32 3
.end_amdhsa_kernel
```
